```python
import torch

def _softmax(x, axis=-1):
    return torch.softmax(x, dim=axis)
def _gelu(x):
    return torch.nn.functional.gelu(x, approximate="tanh")
def _silu(x):
    return torch.nn.functional.silu(x)
def _sigmoid(x):
    return torch.sigmoid(x)
def _layernorm(x, axis=-1, eps=1e-5):
    m = x.mean(dim=axis, keepdim=True)
    v = x.var(dim=axis, keepdim=True, unbiased=False)
    return (x - m) / torch.sqrt(v + eps)
def _scatter_add(tgt, idx, src, axis=0):
    return tgt.clone().index_add_(axis, idx, src)
def _segment_sum(src, seg, n):
    out = torch.zeros((n,) + src.shape[1:], dtype=src.dtype)
    return out.index_add_(0, seg, src)
def _pad(x, pw):
    flat = tuple(v for pair in reversed(pw) for v in pair)
    return torch.nn.functional.pad(x, flat)

kernel_name = 'gated_mix__linear_kernel_hedgehog__linear_kernel_hedgehog__prompt'

def setup_inputs():

    _w = (lambda a: (lambda t: t.to(torch.bfloat16) if t.is_floating_point() else t)(torch.as_tensor(a)))
    def _A_setup():
        B, S, D, H = 1, 2048, 576, 32
        Dh = D // H
        return {
            "x": _w((lambda *s: torch.randn(*s, dtype=torch.bfloat16) * 0.05)(B, S, D)),
            "wqkv": _w((lambda *s: torch.randn(*s, dtype=torch.bfloat16) * 0.8)(D, 3 * D)),
            "w_phi": _w((lambda *s: torch.randn(*s, dtype=torch.bfloat16) * 0.8)(H, Dh, Dh) * (Dh ** -0.5)),
            "wo": _w((lambda *s: torch.randn(*s, dtype=torch.bfloat16) * 0.05)(D, D)),
        }
    _A_in = _A_setup()

    def _B_setup():
        B, S, D, H = 1, 2048, 576, 32
        Dh = D // H
        return {
            "x": _w((lambda *s: torch.randn(*s, dtype=torch.bfloat16) * 0.05)(B, S, D)),
            "wqkv": _w((lambda *s: torch.randn(*s, dtype=torch.bfloat16) * 0.8)(D, 3 * D)),
            "w_phi": _w((lambda *s: torch.randn(*s, dtype=torch.bfloat16) * 0.8)(H, Dh, Dh) * (Dh ** -0.5)),
            "wo": _w((lambda *s: torch.randn(*s, dtype=torch.bfloat16) * 0.05)(D, D)),
        }
    _B_in = _B_setup()

    return {
        "A_x": _A_in["x"],
        "A_wqkv": _A_in["wqkv"],
        "A_w_phi": _A_in["w_phi"],
        "A_wo": _A_in["wo"],
        "B_x": _B_in["x"],
        "B_wqkv": _B_in["wqkv"],
        "B_w_phi": _B_in["w_phi"],
        "B_wo": _B_in["wo"],
        "gate_w": _w((lambda *s: torch.randn(*s, dtype=torch.bfloat16) * 0.05)(576) * 16.0),
    }

def reference(A_x, A_wqkv, A_w_phi, A_wo, B_x, B_wqkv, B_w_phi, B_wo, gate_w):
    def _A_ref(x, wqkv, w_phi, wo):
        B, S, D = x.shape
        H = 32; Dh = D // H
        qkv = (lambda x, *d: x.permute(*d))((x @ wqkv).reshape(B, S, 3, H, Dh), 2, 0, 3, 1, 4)
        q, k, v = qkv[0], qkv[1], qkv[2]
        pq = torch.einsum("bhsd,hdf->bhsf", q, w_phi)
        pk = torch.einsum("bhsd,hdf->bhsf", k, w_phi)
        phi_q = torch.concatenate([_softmax(pq, axis=-1), _softmax(-pq, axis=-1)], axis=-1)
        phi_k = torch.concatenate([_softmax(pk, axis=-1), _softmax(-pk, axis=-1)], axis=-1)
        kv = torch.einsum("bhsf,bhsd->bhfd", phi_k, v)
        z  = torch.einsum("bhsf->bhf", phi_k)
        num = torch.einsum("bhqf,bhfd->bhqd", phi_q, kv)
        den = torch.einsum("bhqf,bhf->bhq", phi_q, z)[..., None] + 1e-6
        o = num / den
        return (lambda x, *d: x.permute(*d))(o, 0, 2, 1, 3).reshape(B, S, D) @ wo

    def _B_ref(x, wqkv, w_phi, wo):
        B, S, D = x.shape
        H = 32; Dh = D // H
        qkv = (lambda x, *d: x.permute(*d))((x @ wqkv).reshape(B, S, 3, H, Dh), 2, 0, 3, 1, 4)
        q, k, v = qkv[0], qkv[1], qkv[2]
        pq = torch.einsum("bhsd,hdf->bhsf", q, w_phi)
        pk = torch.einsum("bhsd,hdf->bhsf", k, w_phi)
        phi_q = torch.concatenate([_softmax(pq, axis=-1), _softmax(-pq, axis=-1)], axis=-1)
        phi_k = torch.concatenate([_softmax(pk, axis=-1), _softmax(-pk, axis=-1)], axis=-1)
        kv = torch.einsum("bhsf,bhsd->bhfd", phi_k, v)
        z  = torch.einsum("bhsf->bhf", phi_k)
        num = torch.einsum("bhqf,bhfd->bhqd", phi_q, kv)
        den = torch.einsum("bhqf,bhf->bhq", phi_q, z)[..., None] + 1e-6
        o = num / den
        return (lambda x, *d: x.permute(*d))(o, 0, 2, 1, 3).reshape(B, S, D) @ wo

    x = A_x
    g = _sigmoid((x * gate_w).sum(-1, keepdims=True))
    a = _A_ref(x, A_wqkv, A_w_phi, A_wo)
    b = _B_ref(x, B_wqkv, B_w_phi, B_wo)
    return g * a + (1 - g) * b
```

```asm
; @launch kernel=hh_k1_kernel grid=(256,1,1) block=(768,1,1) lds=158208
; @launch kernel=hh_k23_kernel grid=(256,1,1) block=(768,1,1) lds=163840
.amdgcn_target "amdgcn-amd-amdhsa--gfx950"
.text
.globl hh_k1_kernel
.type hh_k1_kernel,@function
.globl hh_k23_kernel
.type hh_k23_kernel,@function
.p2align 8
hh_k1_kernel:
    s_cmp_ge_u32 s2, 256
    s_cbranch_scc1 K1_END
    s_load_dwordx16 s[36:51], s[0:1], 0
    s_load_dwordx8 s[52:59], s[0:1], 64
    s_and_b32 s65, s2, 7
    s_lshr_b32 s66, s2, 3
    s_and_b32 s60, s65, 1
    s_lshl_b32 s60, s60, 3
    s_and_b32 s67, s66, 7
    s_add_u32 s60, s60, s67
    s_lshr_b32 s61, s65, 1
    s_lshl_b32 s61, s61, 2
    s_lshr_b32 s67, s66, 3
    s_add_u32 s61, s61, s67
    s_lshr_b32 s62, s61, 3
    s_and_b32 s63, s61, 7
    v_and_b32 v1, 63, v0
    v_lshrrev_b32 v8, 6, v0
    v_lshrrev_b32 v2, 4, v1
    v_readfirstlane_b32 s64, v8
    v_and_b32 v3, 15, v1
    v_lshrrev_b32 v4, 2, v3
    v_and_b32 v5, 3, v3
    s_and_b32 s94, s64, 3
    s_lshr_b32 s95, s64, 2
    s_mov_b32 s75, 0x40000000
    s_mov_b32 s72, 0x3fb8aa3b
    s_mov_b32 s73, 0x3fb8aa3b
    s_cmp_eq_u32 s95, 2
    s_cbranch_scc1 K1_LOADER
    s_lshl_b32 s68, s60, 7
    s_lshl_b32 s67, s94, 5
    s_add_u32 s68, s68, s67
    v_lshrrev_b32 v8, 1, v3
    v_xor_b32 v8, v8, v2
    v_lshlrev_b32 v8, 4, v8
    v_lshl_add_u32 v8, v3, 7, v8
    s_lshl_b32 s67, s94, 12
    s_add_u32 s67, s67, 100352
    v_add_u32 v134, s67, v8
    v_xor_b32 v135, 64, v134
    v_lshl_add_u32 v8, v2, 3, v4
    v_mul_u32_u24 v8, 448, v8
    v_and_b32 v9, 1, v2
    v_lshl_add_u32 v8, v9, 4, v8
    v_lshlrev_b32 v9, 3, v5
    s_mov_b32 s67, 0x68482000
    v_lshrrev_b32 v10, v9, s67
    v_and_b32 v10, 0xff, v10
    v_add_u32 v128, v10, v8
    v_add_u32 v131, 57344, v128
    v_lshlrev_b32 v11, 4, v5
    v_mov_b32 v12, 960
    v_cmp_eq_u32 vcc, v4, v2
    s_nop 1
    v_cndmask_b32 v11, v12, v11, vcc
    v_mul_u32_u24 v12, 1920, v2
    v_add_u32 v11, v11, v12
    v_add_u32 v6, 149504, v11
    s_waitcnt lgkmcnt(0)
    s_mov_b32 s16, s58
    s_and_b32 s17, s59, 0xffff
    s_mov_b32 s18, 0x2000000
    s_mov_b32 s19, 0x20000
    s_cmp_eq_u32 s95, 1
    s_cbranch_scc1 K1_ROLE1
    s_mov_b32 s67, 0x68208800
    v_lshrrev_b32 v10, v9, s67
    v_and_b32 v10, 0xff, v10
    v_add_u32 v129, v10, v8
    v_add_u32 v129, 288, v129
    v_add_u32 v132, 57344, v129
    s_mov_b32 s67, 0x38301810
    v_lshrrev_b32 v10, v9, s67
    v_and_b32 v10, 0xff, v10
    v_add_u32 v130, v10, v8
    v_add_u32 v130, 288, v130
    v_add_u32 v133, 57344, v130
    s_cmp_eq_u32 s62, 0
    s_cselect_b64 s[6:7], s[40:41], s[48:49]
    s_mov_b32 s20, s6
    s_and_b32 s21, s7, 0xffff
    s_mov_b32 s22, 0x5100
    s_mov_b32 s23, 0x20000
    s_lshl_b32 s67, s63, 2
    s_add_u32 s67, s67, s94
    s_mul_i32 s67, s67, 648
    v_mul_u32_u24 v8, 36, v1
    v_add_u32 v8, s67, v8
    v_cmp_gt_u32 vcc, 18, v1
    v_mov_b32 v10, s75
    s_nop 0
    v_cndmask_b32 v8, v10, v8, vcc
    buffer_load_dwordx4 v[136:139], v8, s[20:23], 0 offen
    buffer_load_dwordx4 v[140:143], v8, s[20:23], 0 offen offset:16
    buffer_load_dword v144, v8, s[20:23], 0 offen offset:32
    v_mov_b32 v12, 0
    v_mov_b32 v13, 0
    v_mov_b32 v14, 0
    v_mov_b32 v15, 0
    s_mul_i32 s91, s94, 1920
    s_add_u32 s91, s91, 149504
    v_min_u32 v10, 59, v1
    v_lshl_add_u32 v10, v10, 4, s91
    ds_write_b128 v10, v[12:15]
    ds_write_b128 v10, v[12:15] offset:960
    s_and_b32 s85, s94, 1
    s_lshl_b32 s85, s85, 1
    v_add_u32 v8, s85, v1
    v_lshrrev_b32 v11, 3, v8
    v_and_b32 v8, 7, v8
    v_lshlrev_b32 v8, 1, v8
    v_lshl_add_u32 v8, v11, 6, v8
    v_add_u32 v8, s91, v8
    v_mov_b32 v11, 157184
    v_cmp_gt_u32 vcc, 18, v1
    s_nop 1
    v_cndmask_b32 v8, v11, v8, vcc
    s_waitcnt vmcnt(0)
    ds_write_b16 v8, v136 offset:0
    ds_write_b16_d16_hi v8, v136 offset:16
    ds_write_b16 v8, v137 offset:32
    ds_write_b16_d16_hi v8, v137 offset:48
    ds_write_b16 v8, v138 offset:192
    ds_write_b16_d16_hi v8, v138 offset:208
    ds_write_b16 v8, v139 offset:224
    ds_write_b16_d16_hi v8, v139 offset:240
    ds_write_b16 v8, v140 offset:384
    ds_write_b16_d16_hi v8, v140 offset:400
    s_waitcnt lgkmcnt(0)
    ds_write_b16 v8, v141 offset:416
    ds_write_b16_d16_hi v8, v141 offset:432
    ds_write_b16 v8, v142 offset:576
    ds_write_b16_d16_hi v8, v142 offset:592
    ds_write_b16 v8, v143 offset:608
    ds_write_b16_d16_hi v8, v143 offset:624
    ds_write_b16 v8, v144 offset:768
    ds_write_b16_d16_hi v8, v144 offset:784
    s_waitcnt lgkmcnt(0)
    s_barrier
    ds_read_b128 v[112:115], v134 offset:0
    ds_read_b128 v[116:119], v134 offset:2048
    ds_read_b64_tr_b16 v[80:81], v128 offset:144
    ds_read_b64_tr_b16 v[82:83], v128 offset:1936
    ds_read_b64_tr_b16 v[84:85], v128 offset:152
    ds_read_b64_tr_b16 v[86:87], v128 offset:1944
    ds_read_b64_tr_b16 v[88:89], v128 offset:160
    ds_read_b64_tr_b16 v[90:91], v128 offset:1952
    ds_read_b64_tr_b16 v[92:93], v129 offset:0
    ds_read_b64_tr_b16 v[94:95], v129 offset:1792
    ds_read_b64_tr_b16 v[96:97], v128 offset:168
    ds_read_b64_tr_b16 v[98:99], v128 offset:1960
    ds_read_b64_tr_b16 v[100:101], v128 offset:176
    ds_read_b64_tr_b16 v[102:103], v128 offset:1968
    s_waitcnt lgkmcnt(12)
    s_waitcnt lgkmcnt(6)
    v_mfma_f32_16x16x32_bf16 v[16:19], v[80:83], v[112:115], 0
    ds_read_b64_tr_b16 v[104:105], v128 offset:0
    ds_read_b64_tr_b16 v[106:107], v128 offset:1792
    v_mfma_f32_16x16x32_bf16 v[20:23], v[84:87], v[112:115], 0
    ds_read_b64_tr_b16 v[108:109], v128 offset:8
    ds_read_b64_tr_b16 v[110:111], v128 offset:1800
    v_mfma_f32_16x16x32_bf16 v[24:27], v[88:91], v[112:115], 0
    ds_read_b64_tr_b16 v[80:81], v130 offset:0
    ds_read_b64_tr_b16 v[82:83], v130 offset:1792
    s_waitcnt lgkmcnt(6)
    v_mfma_f32_16x16x32_bf16 v[56:59], v[112:115], v[92:95], 0
    v_mfma_f32_16x16x32_bf16 v[60:63], v[116:119], v[92:95], 0
    ds_read_b64_tr_b16 v[84:85], v128 offset:16
    ds_read_b64_tr_b16 v[86:87], v128 offset:1808
    s_barrier
    ds_read_b128 v[120:123], v135 offset:0
    ds_read_b128 v[124:127], v135 offset:2048
    v_mfma_f32_16x16x32_bf16 v[28:31], v[96:99], v[112:115], 0
    ds_read_b64_tr_b16 v[88:89], v128 offset:24
    ds_read_b64_tr_b16 v[90:91], v128 offset:1816
    v_mfma_f32_16x16x32_bf16 v[32:35], v[100:103], v[112:115], 0
    ds_read_b64_tr_b16 v[92:93], v128 offset:32
    ds_read_b64_tr_b16 v[94:95], v128 offset:1824
    s_waitcnt lgkmcnt(8)
    v_mfma_f32_16x16x32_bf16 v[36:39], v[104:107], v[112:115], 0
    ds_read_b64_tr_b16 v[96:97], v128 offset:14480
    ds_read_b64_tr_b16 v[98:99], v128 offset:16272
    v_mfma_f32_16x16x32_bf16 v[40:43], v[108:111], v[112:115], 0
    ds_read_b64_tr_b16 v[100:101], v128 offset:14488
    ds_read_b64_tr_b16 v[102:103], v128 offset:16280
    v_mfma_f32_16x16x32_bf16 v[64:67], v[112:115], v[80:83], 0
    v_mfma_f32_16x16x32_bf16 v[68:71], v[116:119], v[80:83], 0
    ds_read_b64_tr_b16 v[104:105], v128 offset:14496
    ds_read_b64_tr_b16 v[106:107], v128 offset:16288
    s_waitcnt lgkmcnt(6)
    v_mfma_f32_16x16x32_bf16 v[44:47], v[84:87], v[112:115], 0
    ds_read_b64_tr_b16 v[108:109], v129 offset:14336
    ds_read_b64_tr_b16 v[110:111], v129 offset:16128
    v_mfma_f32_16x16x32_bf16 v[48:51], v[88:91], v[112:115], 0
    ds_read_b64_tr_b16 v[80:81], v128 offset:14504
    ds_read_b64_tr_b16 v[82:83], v128 offset:16296
    v_mfma_f32_16x16x32_bf16 v[52:55], v[92:95], v[112:115], 0
    ds_read_b64_tr_b16 v[84:85], v128 offset:14512
    ds_read_b64_tr_b16 v[86:87], v128 offset:16304
    s_waitcnt lgkmcnt(6)
    v_mfma_f32_16x16x32_bf16 v[16:19], v[96:99], v[120:123], v[16:19]
    ds_read_b64_tr_b16 v[88:89], v128 offset:14336
    ds_read_b64_tr_b16 v[90:91], v128 offset:16128
    v_mfma_f32_16x16x32_bf16 v[20:23], v[100:103], v[120:123], v[20:23]
    ds_read_b64_tr_b16 v[92:93], v128 offset:14344
    ds_read_b64_tr_b16 v[94:95], v128 offset:16136
    v_mfma_f32_16x16x32_bf16 v[24:27], v[104:107], v[120:123], v[24:27]
    ds_read_b64_tr_b16 v[96:97], v130 offset:14336
    ds_read_b64_tr_b16 v[98:99], v130 offset:16128
    s_waitcnt lgkmcnt(6)
    v_mfma_f32_16x16x32_bf16 v[56:59], v[120:123], v[108:111], v[56:59]
    v_mfma_f32_16x16x32_bf16 v[60:63], v[124:127], v[108:111], v[60:63]
    ds_read_b64_tr_b16 v[100:101], v128 offset:14352
    ds_read_b64_tr_b16 v[102:103], v128 offset:16144
    s_barrier
    ds_read_b128 v[112:115], v134 offset:16384
    ds_read_b128 v[116:119], v134 offset:18432
    v_mfma_f32_16x16x32_bf16 v[28:31], v[80:83], v[120:123], v[28:31]
    ds_read_b64_tr_b16 v[104:105], v128 offset:14360
    ds_read_b64_tr_b16 v[106:107], v128 offset:16152
    v_mfma_f32_16x16x32_bf16 v[32:35], v[84:87], v[120:123], v[32:35]
    ds_read_b64_tr_b16 v[108:109], v128 offset:14368
    ds_read_b64_tr_b16 v[110:111], v128 offset:16160
    s_waitcnt lgkmcnt(8)
    v_mfma_f32_16x16x32_bf16 v[36:39], v[88:91], v[120:123], v[36:39]
    ds_read_b64_tr_b16 v[80:81], v128 offset:28816
    ds_read_b64_tr_b16 v[82:83], v128 offset:30608
    v_mfma_f32_16x16x32_bf16 v[40:43], v[92:95], v[120:123], v[40:43]
    ds_read_b64_tr_b16 v[84:85], v128 offset:28824
    ds_read_b64_tr_b16 v[86:87], v128 offset:30616
    v_mfma_f32_16x16x32_bf16 v[64:67], v[120:123], v[96:99], v[64:67]
    v_mfma_f32_16x16x32_bf16 v[68:71], v[124:127], v[96:99], v[68:71]
    ds_read_b64_tr_b16 v[88:89], v128 offset:28832
    ds_read_b64_tr_b16 v[90:91], v128 offset:30624
    s_waitcnt lgkmcnt(6)
    v_mfma_f32_16x16x32_bf16 v[44:47], v[100:103], v[120:123], v[44:47]
    ds_read_b64_tr_b16 v[92:93], v129 offset:28672
    ds_read_b64_tr_b16 v[94:95], v129 offset:30464
    v_mfma_f32_16x16x32_bf16 v[48:51], v[104:107], v[120:123], v[48:51]
    ds_read_b64_tr_b16 v[96:97], v128 offset:28840
    ds_read_b64_tr_b16 v[98:99], v128 offset:30632
    v_mfma_f32_16x16x32_bf16 v[52:55], v[108:111], v[120:123], v[52:55]
    ds_read_b64_tr_b16 v[100:101], v128 offset:28848
    ds_read_b64_tr_b16 v[102:103], v128 offset:30640
    s_waitcnt lgkmcnt(6)
    v_mfma_f32_16x16x32_bf16 v[16:19], v[80:83], v[112:115], v[16:19]
    ds_read_b64_tr_b16 v[104:105], v128 offset:28672
    ds_read_b64_tr_b16 v[106:107], v128 offset:30464
    v_mfma_f32_16x16x32_bf16 v[20:23], v[84:87], v[112:115], v[20:23]
    ds_read_b64_tr_b16 v[108:109], v128 offset:28680
    ds_read_b64_tr_b16 v[110:111], v128 offset:30472
    v_mfma_f32_16x16x32_bf16 v[24:27], v[88:91], v[112:115], v[24:27]
    ds_read_b64_tr_b16 v[80:81], v130 offset:28672
    ds_read_b64_tr_b16 v[82:83], v130 offset:30464
    s_waitcnt lgkmcnt(6)
    v_mfma_f32_16x16x32_bf16 v[56:59], v[112:115], v[92:95], v[56:59]
    v_mfma_f32_16x16x32_bf16 v[60:63], v[116:119], v[92:95], v[60:63]
    ds_read_b64_tr_b16 v[84:85], v128 offset:28688
    ds_read_b64_tr_b16 v[86:87], v128 offset:30480
    s_barrier
    ds_read_b128 v[120:123], v135 offset:16384
    ds_read_b128 v[124:127], v135 offset:18432
    v_mfma_f32_16x16x32_bf16 v[28:31], v[96:99], v[112:115], v[28:31]
    ds_read_b64_tr_b16 v[88:89], v128 offset:28696
    ds_read_b64_tr_b16 v[90:91], v128 offset:30488
    v_mfma_f32_16x16x32_bf16 v[32:35], v[100:103], v[112:115], v[32:35]
    ds_read_b64_tr_b16 v[92:93], v128 offset:28704
    ds_read_b64_tr_b16 v[94:95], v128 offset:30496
    s_waitcnt lgkmcnt(8)
    v_mfma_f32_16x16x32_bf16 v[36:39], v[104:107], v[112:115], v[36:39]
    ds_read_b64_tr_b16 v[96:97], v128 offset:43152
    ds_read_b64_tr_b16 v[98:99], v128 offset:44944
    v_mfma_f32_16x16x32_bf16 v[40:43], v[108:111], v[112:115], v[40:43]
    ds_read_b64_tr_b16 v[100:101], v128 offset:43160
    ds_read_b64_tr_b16 v[102:103], v128 offset:44952
    v_mfma_f32_16x16x32_bf16 v[64:67], v[112:115], v[80:83], v[64:67]
    v_mfma_f32_16x16x32_bf16 v[68:71], v[116:119], v[80:83], v[68:71]
    ds_read_b64_tr_b16 v[104:105], v128 offset:43168
    ds_read_b64_tr_b16 v[106:107], v128 offset:44960
    s_waitcnt lgkmcnt(6)
    v_mfma_f32_16x16x32_bf16 v[44:47], v[84:87], v[112:115], v[44:47]
    ds_read_b64_tr_b16 v[108:109], v129 offset:43008
    ds_read_b64_tr_b16 v[110:111], v129 offset:44800
    v_mfma_f32_16x16x32_bf16 v[48:51], v[88:91], v[112:115], v[48:51]
    ds_read_b64_tr_b16 v[80:81], v128 offset:43176
    ds_read_b64_tr_b16 v[82:83], v128 offset:44968
    v_mfma_f32_16x16x32_bf16 v[52:55], v[92:95], v[112:115], v[52:55]
    ds_read_b64_tr_b16 v[84:85], v128 offset:43184
    ds_read_b64_tr_b16 v[86:87], v128 offset:44976
    s_waitcnt lgkmcnt(6)
    v_mfma_f32_16x16x32_bf16 v[16:19], v[96:99], v[120:123], v[16:19]
    ds_read_b64_tr_b16 v[88:89], v128 offset:43008
    ds_read_b64_tr_b16 v[90:91], v128 offset:44800
    v_mfma_f32_16x16x32_bf16 v[20:23], v[100:103], v[120:123], v[20:23]
    ds_read_b64_tr_b16 v[92:93], v128 offset:43016
    ds_read_b64_tr_b16 v[94:95], v128 offset:44808
    v_mfma_f32_16x16x32_bf16 v[24:27], v[104:107], v[120:123], v[24:27]
    ds_read_b64_tr_b16 v[96:97], v130 offset:43008
    ds_read_b64_tr_b16 v[98:99], v130 offset:44800
    s_waitcnt lgkmcnt(6)
    v_mfma_f32_16x16x32_bf16 v[56:59], v[120:123], v[108:111], v[56:59]
    v_mfma_f32_16x16x32_bf16 v[60:63], v[124:127], v[108:111], v[60:63]
    ds_read_b64_tr_b16 v[100:101], v128 offset:43024
    ds_read_b64_tr_b16 v[102:103], v128 offset:44816
    s_barrier
    ds_read_b128 v[112:115], v134 offset:32768
    ds_read_b128 v[116:119], v134 offset:34816
    v_mfma_f32_16x16x32_bf16 v[28:31], v[80:83], v[120:123], v[28:31]
    ds_read_b64_tr_b16 v[104:105], v128 offset:43032
    ds_read_b64_tr_b16 v[106:107], v128 offset:44824
    v_mfma_f32_16x16x32_bf16 v[32:35], v[84:87], v[120:123], v[32:35]
    ds_read_b64_tr_b16 v[108:109], v128 offset:43040
    ds_read_b64_tr_b16 v[110:111], v128 offset:44832
    s_waitcnt lgkmcnt(8)
    v_mfma_f32_16x16x32_bf16 v[36:39], v[88:91], v[120:123], v[36:39]
    ds_read_b64_tr_b16 v[80:81], v131 offset:144
    ds_read_b64_tr_b16 v[82:83], v131 offset:1936
    v_mfma_f32_16x16x32_bf16 v[40:43], v[92:95], v[120:123], v[40:43]
    ds_read_b64_tr_b16 v[84:85], v131 offset:152
    ds_read_b64_tr_b16 v[86:87], v131 offset:1944
    v_mfma_f32_16x16x32_bf16 v[64:67], v[120:123], v[96:99], v[64:67]
    v_mfma_f32_16x16x32_bf16 v[68:71], v[124:127], v[96:99], v[68:71]
    ds_read_b64_tr_b16 v[88:89], v131 offset:160
    ds_read_b64_tr_b16 v[90:91], v131 offset:1952
    s_waitcnt lgkmcnt(6)
    v_mfma_f32_16x16x32_bf16 v[44:47], v[100:103], v[120:123], v[44:47]
    ds_read_b64_tr_b16 v[92:93], v132 offset:0
    ds_read_b64_tr_b16 v[94:95], v132 offset:1792
    v_mfma_f32_16x16x32_bf16 v[48:51], v[104:107], v[120:123], v[48:51]
    ds_read_b64_tr_b16 v[96:97], v131 offset:168
    ds_read_b64_tr_b16 v[98:99], v131 offset:1960
    v_mfma_f32_16x16x32_bf16 v[52:55], v[108:111], v[120:123], v[52:55]
    ds_read_b64_tr_b16 v[100:101], v131 offset:176
    ds_read_b64_tr_b16 v[102:103], v131 offset:1968
    s_waitcnt lgkmcnt(6)
    v_mfma_f32_16x16x32_bf16 v[16:19], v[80:83], v[112:115], v[16:19]
    ds_read_b64_tr_b16 v[104:105], v131 offset:0
    ds_read_b64_tr_b16 v[106:107], v131 offset:1792
    v_mfma_f32_16x16x32_bf16 v[20:23], v[84:87], v[112:115], v[20:23]
    ds_read_b64_tr_b16 v[108:109], v131 offset:8
    ds_read_b64_tr_b16 v[110:111], v131 offset:1800
    v_mfma_f32_16x16x32_bf16 v[24:27], v[88:91], v[112:115], v[24:27]
    ds_read_b64_tr_b16 v[80:81], v133 offset:0
    ds_read_b64_tr_b16 v[82:83], v133 offset:1792
    s_waitcnt lgkmcnt(6)
    v_mfma_f32_16x16x32_bf16 v[56:59], v[112:115], v[92:95], v[56:59]
    v_mfma_f32_16x16x32_bf16 v[60:63], v[116:119], v[92:95], v[60:63]
    ds_read_b64_tr_b16 v[84:85], v131 offset:16
    ds_read_b64_tr_b16 v[86:87], v131 offset:1808
    s_barrier
    ds_read_b128 v[120:123], v135 offset:32768
    ds_read_b128 v[124:127], v135 offset:34816
    v_mfma_f32_16x16x32_bf16 v[28:31], v[96:99], v[112:115], v[28:31]
    ds_read_b64_tr_b16 v[88:89], v131 offset:24
    ds_read_b64_tr_b16 v[90:91], v131 offset:1816
    v_mfma_f32_16x16x32_bf16 v[32:35], v[100:103], v[112:115], v[32:35]
    ds_read_b64_tr_b16 v[92:93], v131 offset:32
    ds_read_b64_tr_b16 v[94:95], v131 offset:1824
    s_waitcnt lgkmcnt(8)
    v_mfma_f32_16x16x32_bf16 v[36:39], v[104:107], v[112:115], v[36:39]
    ds_read_b64_tr_b16 v[96:97], v131 offset:14480
    ds_read_b64_tr_b16 v[98:99], v131 offset:16272
    v_mfma_f32_16x16x32_bf16 v[40:43], v[108:111], v[112:115], v[40:43]
    ds_read_b64_tr_b16 v[100:101], v131 offset:14488
    ds_read_b64_tr_b16 v[102:103], v131 offset:16280
    v_mfma_f32_16x16x32_bf16 v[64:67], v[112:115], v[80:83], v[64:67]
    v_mfma_f32_16x16x32_bf16 v[68:71], v[116:119], v[80:83], v[68:71]
    ds_read_b64_tr_b16 v[104:105], v131 offset:14496
    ds_read_b64_tr_b16 v[106:107], v131 offset:16288
    s_waitcnt lgkmcnt(6)
    v_mfma_f32_16x16x32_bf16 v[44:47], v[84:87], v[112:115], v[44:47]
    ds_read_b64_tr_b16 v[108:109], v132 offset:14336
    ds_read_b64_tr_b16 v[110:111], v132 offset:16128
    v_mfma_f32_16x16x32_bf16 v[48:51], v[88:91], v[112:115], v[48:51]
    ds_read_b64_tr_b16 v[80:81], v131 offset:14504
    ds_read_b64_tr_b16 v[82:83], v131 offset:16296
    v_mfma_f32_16x16x32_bf16 v[52:55], v[92:95], v[112:115], v[52:55]
    ds_read_b64_tr_b16 v[84:85], v131 offset:14512
    ds_read_b64_tr_b16 v[86:87], v131 offset:16304
    s_waitcnt lgkmcnt(6)
    v_mfma_f32_16x16x32_bf16 v[16:19], v[96:99], v[120:123], v[16:19]
    ds_read_b64_tr_b16 v[88:89], v131 offset:14336
    ds_read_b64_tr_b16 v[90:91], v131 offset:16128
    v_mfma_f32_16x16x32_bf16 v[20:23], v[100:103], v[120:123], v[20:23]
    ds_read_b64_tr_b16 v[92:93], v131 offset:14344
    ds_read_b64_tr_b16 v[94:95], v131 offset:16136
    v_mfma_f32_16x16x32_bf16 v[24:27], v[104:107], v[120:123], v[24:27]
    ds_read_b64_tr_b16 v[96:97], v133 offset:14336
    ds_read_b64_tr_b16 v[98:99], v133 offset:16128
    s_waitcnt lgkmcnt(6)
    v_mfma_f32_16x16x32_bf16 v[56:59], v[120:123], v[108:111], v[56:59]
    v_mfma_f32_16x16x32_bf16 v[60:63], v[124:127], v[108:111], v[60:63]
    ds_read_b64_tr_b16 v[100:101], v131 offset:14352
    ds_read_b64_tr_b16 v[102:103], v131 offset:16144
    s_barrier
    ds_read_b128 v[112:115], v134 offset:0
    ds_read_b128 v[116:119], v134 offset:2048
    v_mfma_f32_16x16x32_bf16 v[28:31], v[80:83], v[120:123], v[28:31]
    ds_read_b64_tr_b16 v[104:105], v131 offset:14360
    ds_read_b64_tr_b16 v[106:107], v131 offset:16152
    v_mfma_f32_16x16x32_bf16 v[32:35], v[84:87], v[120:123], v[32:35]
    ds_read_b64_tr_b16 v[108:109], v131 offset:14368
    ds_read_b64_tr_b16 v[110:111], v131 offset:16160
    s_waitcnt lgkmcnt(8)
    v_mfma_f32_16x16x32_bf16 v[36:39], v[88:91], v[120:123], v[36:39]
    ds_read_b64_tr_b16 v[80:81], v131 offset:28816
    ds_read_b64_tr_b16 v[82:83], v131 offset:30608
    v_mfma_f32_16x16x32_bf16 v[40:43], v[92:95], v[120:123], v[40:43]
    ds_read_b64_tr_b16 v[84:85], v131 offset:28824
    ds_read_b64_tr_b16 v[86:87], v131 offset:30616
    v_mfma_f32_16x16x32_bf16 v[64:67], v[120:123], v[96:99], v[64:67]
    v_mfma_f32_16x16x32_bf16 v[68:71], v[124:127], v[96:99], v[68:71]
    ds_read_b64_tr_b16 v[88:89], v131 offset:28832
    ds_read_b64_tr_b16 v[90:91], v131 offset:30624
    s_waitcnt lgkmcnt(6)
    v_mfma_f32_16x16x32_bf16 v[44:47], v[100:103], v[120:123], v[44:47]
    ds_read_b64_tr_b16 v[92:93], v132 offset:28672
    ds_read_b64_tr_b16 v[94:95], v132 offset:30464
    v_mfma_f32_16x16x32_bf16 v[48:51], v[104:107], v[120:123], v[48:51]
    ds_read_b64_tr_b16 v[96:97], v131 offset:28840
    ds_read_b64_tr_b16 v[98:99], v131 offset:30632
    v_mfma_f32_16x16x32_bf16 v[52:55], v[108:111], v[120:123], v[52:55]
    ds_read_b64_tr_b16 v[100:101], v131 offset:28848
    ds_read_b64_tr_b16 v[102:103], v131 offset:30640
    s_waitcnt lgkmcnt(6)
    v_mfma_f32_16x16x32_bf16 v[16:19], v[80:83], v[112:115], v[16:19]
    ds_read_b64_tr_b16 v[104:105], v131 offset:28672
    ds_read_b64_tr_b16 v[106:107], v131 offset:30464
    v_mfma_f32_16x16x32_bf16 v[20:23], v[84:87], v[112:115], v[20:23]
    ds_read_b64_tr_b16 v[108:109], v131 offset:28680
    ds_read_b64_tr_b16 v[110:111], v131 offset:30472
    v_mfma_f32_16x16x32_bf16 v[24:27], v[88:91], v[112:115], v[24:27]
    ds_read_b64_tr_b16 v[80:81], v133 offset:28672
    ds_read_b64_tr_b16 v[82:83], v133 offset:30464
    s_waitcnt lgkmcnt(6)
    v_mfma_f32_16x16x32_bf16 v[56:59], v[112:115], v[92:95], v[56:59]
    v_mfma_f32_16x16x32_bf16 v[60:63], v[116:119], v[92:95], v[60:63]
    ds_read_b64_tr_b16 v[84:85], v131 offset:28688
    ds_read_b64_tr_b16 v[86:87], v131 offset:30480
    s_barrier
    ds_read_b128 v[120:123], v135 offset:0
    ds_read_b128 v[124:127], v135 offset:2048
    v_mfma_f32_16x16x32_bf16 v[28:31], v[96:99], v[112:115], v[28:31]
    ds_read_b64_tr_b16 v[88:89], v131 offset:28696
    ds_read_b64_tr_b16 v[90:91], v131 offset:30488
    v_mfma_f32_16x16x32_bf16 v[32:35], v[100:103], v[112:115], v[32:35]
    ds_read_b64_tr_b16 v[92:93], v131 offset:28704
    ds_read_b64_tr_b16 v[94:95], v131 offset:30496
    s_waitcnt lgkmcnt(8)
    v_mfma_f32_16x16x32_bf16 v[36:39], v[104:107], v[112:115], v[36:39]
    ds_read_b64_tr_b16 v[96:97], v128 offset:144
    ds_read_b64_tr_b16 v[98:99], v128 offset:1936
    v_mfma_f32_16x16x32_bf16 v[40:43], v[108:111], v[112:115], v[40:43]
    ds_read_b64_tr_b16 v[100:101], v128 offset:152
    ds_read_b64_tr_b16 v[102:103], v128 offset:1944
    v_mfma_f32_16x16x32_bf16 v[64:67], v[112:115], v[80:83], v[64:67]
    v_mfma_f32_16x16x32_bf16 v[68:71], v[116:119], v[80:83], v[68:71]
    ds_read_b64_tr_b16 v[104:105], v128 offset:160
    ds_read_b64_tr_b16 v[106:107], v128 offset:1952
    s_waitcnt lgkmcnt(6)
    v_mfma_f32_16x16x32_bf16 v[44:47], v[84:87], v[112:115], v[44:47]
    ds_read_b64_tr_b16 v[108:109], v129 offset:0
    ds_read_b64_tr_b16 v[110:111], v129 offset:1792
    v_mfma_f32_16x16x32_bf16 v[48:51], v[88:91], v[112:115], v[48:51]
    ds_read_b64_tr_b16 v[80:81], v128 offset:168
    ds_read_b64_tr_b16 v[82:83], v128 offset:1960
    v_mfma_f32_16x16x32_bf16 v[52:55], v[92:95], v[112:115], v[52:55]
    ds_read_b64_tr_b16 v[84:85], v128 offset:176
    ds_read_b64_tr_b16 v[86:87], v128 offset:1968
    s_waitcnt lgkmcnt(6)
    v_mfma_f32_16x16x32_bf16 v[16:19], v[96:99], v[120:123], v[16:19]
    ds_read_b64_tr_b16 v[88:89], v128 offset:0
    ds_read_b64_tr_b16 v[90:91], v128 offset:1792
    v_mfma_f32_16x16x32_bf16 v[20:23], v[100:103], v[120:123], v[20:23]
    ds_read_b64_tr_b16 v[92:93], v128 offset:8
    ds_read_b64_tr_b16 v[94:95], v128 offset:1800
    v_mfma_f32_16x16x32_bf16 v[24:27], v[104:107], v[120:123], v[24:27]
    ds_read_b64_tr_b16 v[96:97], v130 offset:0
    ds_read_b64_tr_b16 v[98:99], v130 offset:1792
    s_waitcnt lgkmcnt(6)
    v_mfma_f32_16x16x32_bf16 v[56:59], v[120:123], v[108:111], v[56:59]
    v_mfma_f32_16x16x32_bf16 v[60:63], v[124:127], v[108:111], v[60:63]
    ds_read_b64_tr_b16 v[100:101], v128 offset:16
    ds_read_b64_tr_b16 v[102:103], v128 offset:1808
    s_barrier
    ds_read_b128 v[112:115], v134 offset:16384
    ds_read_b128 v[116:119], v134 offset:18432
    v_mfma_f32_16x16x32_bf16 v[28:31], v[80:83], v[120:123], v[28:31]
    ds_read_b64_tr_b16 v[104:105], v128 offset:24
    ds_read_b64_tr_b16 v[106:107], v128 offset:1816
    v_mfma_f32_16x16x32_bf16 v[32:35], v[84:87], v[120:123], v[32:35]
    ds_read_b64_tr_b16 v[108:109], v128 offset:32
    ds_read_b64_tr_b16 v[110:111], v128 offset:1824
    s_waitcnt lgkmcnt(8)
    v_mfma_f32_16x16x32_bf16 v[36:39], v[88:91], v[120:123], v[36:39]
    ds_read_b64_tr_b16 v[80:81], v128 offset:14480
    ds_read_b64_tr_b16 v[82:83], v128 offset:16272
    v_mfma_f32_16x16x32_bf16 v[40:43], v[92:95], v[120:123], v[40:43]
    ds_read_b64_tr_b16 v[84:85], v128 offset:14488
    ds_read_b64_tr_b16 v[86:87], v128 offset:16280
    v_mfma_f32_16x16x32_bf16 v[64:67], v[120:123], v[96:99], v[64:67]
    v_mfma_f32_16x16x32_bf16 v[68:71], v[124:127], v[96:99], v[68:71]
    ds_read_b64_tr_b16 v[88:89], v128 offset:14496
    ds_read_b64_tr_b16 v[90:91], v128 offset:16288
    s_waitcnt lgkmcnt(6)
    v_mfma_f32_16x16x32_bf16 v[44:47], v[100:103], v[120:123], v[44:47]
    ds_read_b64_tr_b16 v[92:93], v129 offset:14336
    ds_read_b64_tr_b16 v[94:95], v129 offset:16128
    v_mfma_f32_16x16x32_bf16 v[48:51], v[104:107], v[120:123], v[48:51]
    ds_read_b64_tr_b16 v[96:97], v128 offset:14504
    ds_read_b64_tr_b16 v[98:99], v128 offset:16296
    v_mfma_f32_16x16x32_bf16 v[52:55], v[108:111], v[120:123], v[52:55]
    ds_read_b64_tr_b16 v[100:101], v128 offset:14512
    ds_read_b64_tr_b16 v[102:103], v128 offset:16304
    s_waitcnt lgkmcnt(6)
    v_mfma_f32_16x16x32_bf16 v[16:19], v[80:83], v[112:115], v[16:19]
    ds_read_b64_tr_b16 v[104:105], v128 offset:14336
    ds_read_b64_tr_b16 v[106:107], v128 offset:16128
    v_mfma_f32_16x16x32_bf16 v[20:23], v[84:87], v[112:115], v[20:23]
    ds_read_b64_tr_b16 v[108:109], v128 offset:14344
    ds_read_b64_tr_b16 v[110:111], v128 offset:16136
    v_mfma_f32_16x16x32_bf16 v[24:27], v[88:91], v[112:115], v[24:27]
    ds_read_b64_tr_b16 v[80:81], v130 offset:14336
    ds_read_b64_tr_b16 v[82:83], v130 offset:16128
    s_waitcnt lgkmcnt(6)
    v_mfma_f32_16x16x32_bf16 v[56:59], v[112:115], v[92:95], v[56:59]
    v_mfma_f32_16x16x32_bf16 v[60:63], v[116:119], v[92:95], v[60:63]
    ds_read_b64_tr_b16 v[84:85], v128 offset:14352
    ds_read_b64_tr_b16 v[86:87], v128 offset:16144
    s_barrier
    ds_read_b128 v[120:123], v135 offset:16384
    ds_read_b128 v[124:127], v135 offset:18432
    v_mfma_f32_16x16x32_bf16 v[28:31], v[96:99], v[112:115], v[28:31]
    ds_read_b64_tr_b16 v[88:89], v128 offset:14360
    ds_read_b64_tr_b16 v[90:91], v128 offset:16152
    v_mfma_f32_16x16x32_bf16 v[32:35], v[100:103], v[112:115], v[32:35]
    ds_read_b64_tr_b16 v[92:93], v128 offset:14368
    ds_read_b64_tr_b16 v[94:95], v128 offset:16160
    s_waitcnt lgkmcnt(8)
    v_mfma_f32_16x16x32_bf16 v[36:39], v[104:107], v[112:115], v[36:39]
    ds_read_b64_tr_b16 v[96:97], v128 offset:28816
    ds_read_b64_tr_b16 v[98:99], v128 offset:30608
    v_mfma_f32_16x16x32_bf16 v[40:43], v[108:111], v[112:115], v[40:43]
    ds_read_b64_tr_b16 v[100:101], v128 offset:28824
    ds_read_b64_tr_b16 v[102:103], v128 offset:30616
    v_mfma_f32_16x16x32_bf16 v[64:67], v[112:115], v[80:83], v[64:67]
    v_mfma_f32_16x16x32_bf16 v[68:71], v[116:119], v[80:83], v[68:71]
    ds_read_b64_tr_b16 v[104:105], v128 offset:28832
    ds_read_b64_tr_b16 v[106:107], v128 offset:30624
    s_waitcnt lgkmcnt(6)
    v_mfma_f32_16x16x32_bf16 v[44:47], v[84:87], v[112:115], v[44:47]
    ds_read_b64_tr_b16 v[108:109], v129 offset:28672
    ds_read_b64_tr_b16 v[110:111], v129 offset:30464
    v_mfma_f32_16x16x32_bf16 v[48:51], v[88:91], v[112:115], v[48:51]
    ds_read_b64_tr_b16 v[80:81], v128 offset:28840
    ds_read_b64_tr_b16 v[82:83], v128 offset:30632
    v_mfma_f32_16x16x32_bf16 v[52:55], v[92:95], v[112:115], v[52:55]
    ds_read_b64_tr_b16 v[84:85], v128 offset:28848
    ds_read_b64_tr_b16 v[86:87], v128 offset:30640
    s_waitcnt lgkmcnt(6)
    v_mfma_f32_16x16x32_bf16 v[16:19], v[96:99], v[120:123], v[16:19]
    ds_read_b64_tr_b16 v[88:89], v128 offset:28672
    ds_read_b64_tr_b16 v[90:91], v128 offset:30464
    v_mfma_f32_16x16x32_bf16 v[20:23], v[100:103], v[120:123], v[20:23]
    ds_read_b64_tr_b16 v[92:93], v128 offset:28680
    ds_read_b64_tr_b16 v[94:95], v128 offset:30472
    v_mfma_f32_16x16x32_bf16 v[24:27], v[104:107], v[120:123], v[24:27]
    ds_read_b64_tr_b16 v[96:97], v130 offset:28672
    ds_read_b64_tr_b16 v[98:99], v130 offset:30464
    s_waitcnt lgkmcnt(6)
    v_mfma_f32_16x16x32_bf16 v[56:59], v[120:123], v[108:111], v[56:59]
    v_mfma_f32_16x16x32_bf16 v[60:63], v[124:127], v[108:111], v[60:63]
    ds_read_b64_tr_b16 v[100:101], v128 offset:28688
    ds_read_b64_tr_b16 v[102:103], v128 offset:30480
    s_barrier
    ds_read_b128 v[112:115], v134 offset:32768
    ds_read_b128 v[116:119], v134 offset:34816
    v_mfma_f32_16x16x32_bf16 v[28:31], v[80:83], v[120:123], v[28:31]
    ds_read_b64_tr_b16 v[104:105], v128 offset:28696
    ds_read_b64_tr_b16 v[106:107], v128 offset:30488
    v_mfma_f32_16x16x32_bf16 v[32:35], v[84:87], v[120:123], v[32:35]
    ds_read_b64_tr_b16 v[108:109], v128 offset:28704
    ds_read_b64_tr_b16 v[110:111], v128 offset:30496
    s_waitcnt lgkmcnt(8)
    v_mfma_f32_16x16x32_bf16 v[36:39], v[88:91], v[120:123], v[36:39]
    ds_read_b64_tr_b16 v[80:81], v128 offset:43152
    ds_read_b64_tr_b16 v[82:83], v128 offset:44944
    v_mfma_f32_16x16x32_bf16 v[40:43], v[92:95], v[120:123], v[40:43]
    ds_read_b64_tr_b16 v[84:85], v128 offset:43160
    ds_read_b64_tr_b16 v[86:87], v128 offset:44952
    v_mfma_f32_16x16x32_bf16 v[64:67], v[120:123], v[96:99], v[64:67]
    v_mfma_f32_16x16x32_bf16 v[68:71], v[124:127], v[96:99], v[68:71]
    ds_read_b64_tr_b16 v[88:89], v128 offset:43168
    ds_read_b64_tr_b16 v[90:91], v128 offset:44960
    s_waitcnt lgkmcnt(6)
    v_mfma_f32_16x16x32_bf16 v[44:47], v[100:103], v[120:123], v[44:47]
    ds_read_b64_tr_b16 v[92:93], v129 offset:43008
    ds_read_b64_tr_b16 v[94:95], v129 offset:44800
    v_mfma_f32_16x16x32_bf16 v[48:51], v[104:107], v[120:123], v[48:51]
    ds_read_b64_tr_b16 v[96:97], v128 offset:43176
    ds_read_b64_tr_b16 v[98:99], v128 offset:44968
    v_mfma_f32_16x16x32_bf16 v[52:55], v[108:111], v[120:123], v[52:55]
    ds_read_b64_tr_b16 v[100:101], v128 offset:43184
    ds_read_b64_tr_b16 v[102:103], v128 offset:44976
    s_waitcnt lgkmcnt(6)
    v_mfma_f32_16x16x32_bf16 v[16:19], v[80:83], v[112:115], v[16:19]
    ds_read_b64_tr_b16 v[104:105], v128 offset:43008
    ds_read_b64_tr_b16 v[106:107], v128 offset:44800
    v_mfma_f32_16x16x32_bf16 v[20:23], v[84:87], v[112:115], v[20:23]
    ds_read_b64_tr_b16 v[108:109], v128 offset:43016
    ds_read_b64_tr_b16 v[110:111], v128 offset:44808
    v_mfma_f32_16x16x32_bf16 v[24:27], v[88:91], v[112:115], v[24:27]
    ds_read_b64_tr_b16 v[80:81], v130 offset:43008
    ds_read_b64_tr_b16 v[82:83], v130 offset:44800
    s_waitcnt lgkmcnt(6)
    v_mfma_f32_16x16x32_bf16 v[56:59], v[112:115], v[92:95], v[56:59]
    v_mfma_f32_16x16x32_bf16 v[60:63], v[116:119], v[92:95], v[60:63]
    ds_read_b64_tr_b16 v[84:85], v128 offset:43024
    ds_read_b64_tr_b16 v[86:87], v128 offset:44816
    s_barrier
    ds_read_b128 v[120:123], v135 offset:32768
    ds_read_b128 v[124:127], v135 offset:34816
    v_mfma_f32_16x16x32_bf16 v[28:31], v[96:99], v[112:115], v[28:31]
    ds_read_b64_tr_b16 v[88:89], v128 offset:43032
    ds_read_b64_tr_b16 v[90:91], v128 offset:44824
    v_mfma_f32_16x16x32_bf16 v[32:35], v[100:103], v[112:115], v[32:35]
    ds_read_b64_tr_b16 v[92:93], v128 offset:43040
    ds_read_b64_tr_b16 v[94:95], v128 offset:44832
    s_waitcnt lgkmcnt(8)
    v_mfma_f32_16x16x32_bf16 v[36:39], v[104:107], v[112:115], v[36:39]
    ds_read_b64_tr_b16 v[96:97], v131 offset:144
    ds_read_b64_tr_b16 v[98:99], v131 offset:1936
    v_mfma_f32_16x16x32_bf16 v[40:43], v[108:111], v[112:115], v[40:43]
    ds_read_b64_tr_b16 v[100:101], v131 offset:152
    ds_read_b64_tr_b16 v[102:103], v131 offset:1944
    v_mfma_f32_16x16x32_bf16 v[64:67], v[112:115], v[80:83], v[64:67]
    v_mfma_f32_16x16x32_bf16 v[68:71], v[116:119], v[80:83], v[68:71]
    ds_read_b64_tr_b16 v[104:105], v131 offset:160
    ds_read_b64_tr_b16 v[106:107], v131 offset:1952
    s_waitcnt lgkmcnt(6)
    v_mfma_f32_16x16x32_bf16 v[44:47], v[84:87], v[112:115], v[44:47]
    ds_read_b64_tr_b16 v[108:109], v132 offset:0
    ds_read_b64_tr_b16 v[110:111], v132 offset:1792
    v_mfma_f32_16x16x32_bf16 v[48:51], v[88:91], v[112:115], v[48:51]
    ds_read_b64_tr_b16 v[80:81], v131 offset:168
    ds_read_b64_tr_b16 v[82:83], v131 offset:1960
    v_mfma_f32_16x16x32_bf16 v[52:55], v[92:95], v[112:115], v[52:55]
    ds_read_b64_tr_b16 v[84:85], v131 offset:176
    ds_read_b64_tr_b16 v[86:87], v131 offset:1968
    s_waitcnt lgkmcnt(6)
    v_mfma_f32_16x16x32_bf16 v[16:19], v[96:99], v[120:123], v[16:19]
    ds_read_b64_tr_b16 v[88:89], v131 offset:0
    ds_read_b64_tr_b16 v[90:91], v131 offset:1792
    v_mfma_f32_16x16x32_bf16 v[20:23], v[100:103], v[120:123], v[20:23]
    ds_read_b64_tr_b16 v[92:93], v131 offset:8
    ds_read_b64_tr_b16 v[94:95], v131 offset:1800
    v_mfma_f32_16x16x32_bf16 v[24:27], v[104:107], v[120:123], v[24:27]
    ds_read_b64_tr_b16 v[96:97], v133 offset:0
    ds_read_b64_tr_b16 v[98:99], v133 offset:1792
    s_waitcnt lgkmcnt(6)
    v_mfma_f32_16x16x32_bf16 v[56:59], v[120:123], v[108:111], v[56:59]
    v_mfma_f32_16x16x32_bf16 v[60:63], v[124:127], v[108:111], v[60:63]
    ds_read_b64_tr_b16 v[100:101], v131 offset:16
    ds_read_b64_tr_b16 v[102:103], v131 offset:1808
    s_barrier
    ds_read_b128 v[112:115], v134 offset:0
    ds_read_b128 v[116:119], v134 offset:2048
    v_mfma_f32_16x16x32_bf16 v[28:31], v[80:83], v[120:123], v[28:31]
    ds_read_b64_tr_b16 v[104:105], v131 offset:24
    ds_read_b64_tr_b16 v[106:107], v131 offset:1816
    v_mfma_f32_16x16x32_bf16 v[32:35], v[84:87], v[120:123], v[32:35]
    ds_read_b64_tr_b16 v[108:109], v131 offset:32
    ds_read_b64_tr_b16 v[110:111], v131 offset:1824
    s_waitcnt lgkmcnt(8)
    v_mfma_f32_16x16x32_bf16 v[36:39], v[88:91], v[120:123], v[36:39]
    ds_read_b64_tr_b16 v[80:81], v131 offset:14480
    ds_read_b64_tr_b16 v[82:83], v131 offset:16272
    v_mfma_f32_16x16x32_bf16 v[40:43], v[92:95], v[120:123], v[40:43]
    ds_read_b64_tr_b16 v[84:85], v131 offset:14488
    ds_read_b64_tr_b16 v[86:87], v131 offset:16280
    v_mfma_f32_16x16x32_bf16 v[64:67], v[120:123], v[96:99], v[64:67]
    v_mfma_f32_16x16x32_bf16 v[68:71], v[124:127], v[96:99], v[68:71]
    ds_read_b64_tr_b16 v[88:89], v131 offset:14496
    ds_read_b64_tr_b16 v[90:91], v131 offset:16288
    s_waitcnt lgkmcnt(6)
    v_mfma_f32_16x16x32_bf16 v[44:47], v[100:103], v[120:123], v[44:47]
    ds_read_b64_tr_b16 v[92:93], v132 offset:14336
    ds_read_b64_tr_b16 v[94:95], v132 offset:16128
    v_mfma_f32_16x16x32_bf16 v[48:51], v[104:107], v[120:123], v[48:51]
    ds_read_b64_tr_b16 v[96:97], v131 offset:14504
    ds_read_b64_tr_b16 v[98:99], v131 offset:16296
    v_mfma_f32_16x16x32_bf16 v[52:55], v[108:111], v[120:123], v[52:55]
    ds_read_b64_tr_b16 v[100:101], v131 offset:14512
    ds_read_b64_tr_b16 v[102:103], v131 offset:16304
    s_waitcnt lgkmcnt(6)
    v_mfma_f32_16x16x32_bf16 v[16:19], v[80:83], v[112:115], v[16:19]
    ds_read_b64_tr_b16 v[104:105], v131 offset:14336
    ds_read_b64_tr_b16 v[106:107], v131 offset:16128
    v_mfma_f32_16x16x32_bf16 v[20:23], v[84:87], v[112:115], v[20:23]
    ds_read_b64_tr_b16 v[108:109], v131 offset:14344
    ds_read_b64_tr_b16 v[110:111], v131 offset:16136
    v_mfma_f32_16x16x32_bf16 v[24:27], v[88:91], v[112:115], v[24:27]
    ds_read_b64_tr_b16 v[80:81], v133 offset:14336
    ds_read_b64_tr_b16 v[82:83], v133 offset:16128
    s_waitcnt lgkmcnt(6)
    v_mfma_f32_16x16x32_bf16 v[56:59], v[112:115], v[92:95], v[56:59]
    v_mfma_f32_16x16x32_bf16 v[60:63], v[116:119], v[92:95], v[60:63]
    ds_read_b64_tr_b16 v[84:85], v131 offset:14352
    ds_read_b64_tr_b16 v[86:87], v131 offset:16144
    s_barrier
    ds_read_b128 v[120:123], v135 offset:0
    ds_read_b128 v[124:127], v135 offset:2048
    v_mfma_f32_16x16x32_bf16 v[28:31], v[96:99], v[112:115], v[28:31]
    ds_read_b64_tr_b16 v[88:89], v131 offset:14360
    ds_read_b64_tr_b16 v[90:91], v131 offset:16152
    v_mfma_f32_16x16x32_bf16 v[32:35], v[100:103], v[112:115], v[32:35]
    ds_read_b64_tr_b16 v[92:93], v131 offset:14368
    ds_read_b64_tr_b16 v[94:95], v131 offset:16160
    s_waitcnt lgkmcnt(8)
    v_mfma_f32_16x16x32_bf16 v[36:39], v[104:107], v[112:115], v[36:39]
    ds_read_b64_tr_b16 v[96:97], v131 offset:28816
    ds_read_b64_tr_b16 v[98:99], v131 offset:30608
    v_mfma_f32_16x16x32_bf16 v[40:43], v[108:111], v[112:115], v[40:43]
    ds_read_b64_tr_b16 v[100:101], v131 offset:28824
    ds_read_b64_tr_b16 v[102:103], v131 offset:30616
    v_mfma_f32_16x16x32_bf16 v[64:67], v[112:115], v[80:83], v[64:67]
    v_mfma_f32_16x16x32_bf16 v[68:71], v[116:119], v[80:83], v[68:71]
    ds_read_b64_tr_b16 v[104:105], v131 offset:28832
    ds_read_b64_tr_b16 v[106:107], v131 offset:30624
    s_waitcnt lgkmcnt(6)
    v_mfma_f32_16x16x32_bf16 v[44:47], v[84:87], v[112:115], v[44:47]
    ds_read_b64_tr_b16 v[108:109], v132 offset:28672
    ds_read_b64_tr_b16 v[110:111], v132 offset:30464
    v_mfma_f32_16x16x32_bf16 v[48:51], v[88:91], v[112:115], v[48:51]
    ds_read_b64_tr_b16 v[80:81], v131 offset:28840
    ds_read_b64_tr_b16 v[82:83], v131 offset:30632
    v_mfma_f32_16x16x32_bf16 v[52:55], v[92:95], v[112:115], v[52:55]
    ds_read_b64_tr_b16 v[84:85], v131 offset:28848
    ds_read_b64_tr_b16 v[86:87], v131 offset:30640
    s_waitcnt lgkmcnt(6)
    v_mfma_f32_16x16x32_bf16 v[16:19], v[96:99], v[120:123], v[16:19]
    ds_read_b64_tr_b16 v[88:89], v131 offset:28672
    ds_read_b64_tr_b16 v[90:91], v131 offset:30464
    v_mfma_f32_16x16x32_bf16 v[20:23], v[100:103], v[120:123], v[20:23]
    ds_read_b64_tr_b16 v[92:93], v131 offset:28680
    ds_read_b64_tr_b16 v[94:95], v131 offset:30472
    v_mfma_f32_16x16x32_bf16 v[24:27], v[104:107], v[120:123], v[24:27]
    ds_read_b64_tr_b16 v[96:97], v133 offset:28672
    ds_read_b64_tr_b16 v[98:99], v133 offset:30464
    s_waitcnt lgkmcnt(6)
    v_mfma_f32_16x16x32_bf16 v[56:59], v[120:123], v[108:111], v[56:59]
    v_mfma_f32_16x16x32_bf16 v[60:63], v[124:127], v[108:111], v[60:63]
    ds_read_b64_tr_b16 v[100:101], v131 offset:28688
    ds_read_b64_tr_b16 v[102:103], v131 offset:30480
    s_barrier
    ds_read_b128 v[112:115], v134 offset:16384
    ds_read_b128 v[116:119], v134 offset:18432
    v_mfma_f32_16x16x32_bf16 v[28:31], v[80:83], v[120:123], v[28:31]
    ds_read_b64_tr_b16 v[104:105], v131 offset:28696
    ds_read_b64_tr_b16 v[106:107], v131 offset:30488
    v_mfma_f32_16x16x32_bf16 v[32:35], v[84:87], v[120:123], v[32:35]
    ds_read_b64_tr_b16 v[108:109], v131 offset:28704
    ds_read_b64_tr_b16 v[110:111], v131 offset:30496
    s_waitcnt lgkmcnt(8)
    v_mfma_f32_16x16x32_bf16 v[36:39], v[88:91], v[120:123], v[36:39]
    ds_read_b64_tr_b16 v[80:81], v128 offset:144
    ds_read_b64_tr_b16 v[82:83], v128 offset:1936
    v_mfma_f32_16x16x32_bf16 v[40:43], v[92:95], v[120:123], v[40:43]
    ds_read_b64_tr_b16 v[84:85], v128 offset:152
    ds_read_b64_tr_b16 v[86:87], v128 offset:1944
    v_mfma_f32_16x16x32_bf16 v[64:67], v[120:123], v[96:99], v[64:67]
    v_mfma_f32_16x16x32_bf16 v[68:71], v[124:127], v[96:99], v[68:71]
    ds_read_b64_tr_b16 v[88:89], v128 offset:160
    ds_read_b64_tr_b16 v[90:91], v128 offset:1952
    s_waitcnt lgkmcnt(6)
    v_mfma_f32_16x16x32_bf16 v[44:47], v[100:103], v[120:123], v[44:47]
    ds_read_b64_tr_b16 v[92:93], v129 offset:0
    ds_read_b64_tr_b16 v[94:95], v129 offset:1792
    v_mfma_f32_16x16x32_bf16 v[48:51], v[104:107], v[120:123], v[48:51]
    ds_read_b64_tr_b16 v[96:97], v128 offset:168
    ds_read_b64_tr_b16 v[98:99], v128 offset:1960
    v_mfma_f32_16x16x32_bf16 v[52:55], v[108:111], v[120:123], v[52:55]
    ds_read_b64_tr_b16 v[100:101], v128 offset:176
    ds_read_b64_tr_b16 v[102:103], v128 offset:1968
    s_waitcnt lgkmcnt(6)
    v_mfma_f32_16x16x32_bf16 v[16:19], v[80:83], v[112:115], v[16:19]
    ds_read_b64_tr_b16 v[104:105], v128 offset:0
    ds_read_b64_tr_b16 v[106:107], v128 offset:1792
    v_mfma_f32_16x16x32_bf16 v[20:23], v[84:87], v[112:115], v[20:23]
    ds_read_b64_tr_b16 v[108:109], v128 offset:8
    ds_read_b64_tr_b16 v[110:111], v128 offset:1800
    v_mfma_f32_16x16x32_bf16 v[24:27], v[88:91], v[112:115], v[24:27]
    ds_read_b64_tr_b16 v[80:81], v130 offset:0
    ds_read_b64_tr_b16 v[82:83], v130 offset:1792
    s_waitcnt lgkmcnt(6)
    v_mfma_f32_16x16x32_bf16 v[56:59], v[112:115], v[92:95], v[56:59]
    v_mfma_f32_16x16x32_bf16 v[60:63], v[116:119], v[92:95], v[60:63]
    ds_read_b64_tr_b16 v[84:85], v128 offset:16
    ds_read_b64_tr_b16 v[86:87], v128 offset:1808
    s_barrier
    ds_read_b128 v[120:123], v135 offset:16384
    ds_read_b128 v[124:127], v135 offset:18432
    v_mfma_f32_16x16x32_bf16 v[28:31], v[96:99], v[112:115], v[28:31]
    ds_read_b64_tr_b16 v[88:89], v128 offset:24
    ds_read_b64_tr_b16 v[90:91], v128 offset:1816
    v_mfma_f32_16x16x32_bf16 v[32:35], v[100:103], v[112:115], v[32:35]
    ds_read_b64_tr_b16 v[92:93], v128 offset:32
    ds_read_b64_tr_b16 v[94:95], v128 offset:1824
    s_waitcnt lgkmcnt(8)
    v_mfma_f32_16x16x32_bf16 v[36:39], v[104:107], v[112:115], v[36:39]
    ds_read_b64_tr_b16 v[96:97], v128 offset:14480
    ds_read_b64_tr_b16 v[98:99], v128 offset:16272
    v_mfma_f32_16x16x32_bf16 v[40:43], v[108:111], v[112:115], v[40:43]
    ds_read_b64_tr_b16 v[100:101], v128 offset:14488
    ds_read_b64_tr_b16 v[102:103], v128 offset:16280
    v_mfma_f32_16x16x32_bf16 v[64:67], v[112:115], v[80:83], v[64:67]
    v_mfma_f32_16x16x32_bf16 v[68:71], v[116:119], v[80:83], v[68:71]
    ds_read_b64_tr_b16 v[104:105], v128 offset:14496
    ds_read_b64_tr_b16 v[106:107], v128 offset:16288
    s_waitcnt lgkmcnt(6)
    v_mfma_f32_16x16x32_bf16 v[44:47], v[84:87], v[112:115], v[44:47]
    ds_read_b64_tr_b16 v[108:109], v129 offset:14336
    ds_read_b64_tr_b16 v[110:111], v129 offset:16128
    v_mfma_f32_16x16x32_bf16 v[48:51], v[88:91], v[112:115], v[48:51]
    ds_read_b64_tr_b16 v[80:81], v128 offset:14504
    ds_read_b64_tr_b16 v[82:83], v128 offset:16296
    v_mfma_f32_16x16x32_bf16 v[52:55], v[92:95], v[112:115], v[52:55]
    ds_read_b64_tr_b16 v[84:85], v128 offset:14512
    ds_read_b64_tr_b16 v[86:87], v128 offset:16304
    s_waitcnt lgkmcnt(6)
    v_mfma_f32_16x16x32_bf16 v[16:19], v[96:99], v[120:123], v[16:19]
    ds_read_b64_tr_b16 v[88:89], v128 offset:14336
    ds_read_b64_tr_b16 v[90:91], v128 offset:16128
    v_mfma_f32_16x16x32_bf16 v[20:23], v[100:103], v[120:123], v[20:23]
    ds_read_b64_tr_b16 v[92:93], v128 offset:14344
    ds_read_b64_tr_b16 v[94:95], v128 offset:16136
    v_mfma_f32_16x16x32_bf16 v[24:27], v[104:107], v[120:123], v[24:27]
    ds_read_b64_tr_b16 v[96:97], v130 offset:14336
    ds_read_b64_tr_b16 v[98:99], v130 offset:16128
    s_waitcnt lgkmcnt(6)
    v_mfma_f32_16x16x32_bf16 v[56:59], v[120:123], v[108:111], v[56:59]
    v_mfma_f32_16x16x32_bf16 v[60:63], v[124:127], v[108:111], v[60:63]
    ds_read_b64_tr_b16 v[100:101], v128 offset:14352
    ds_read_b64_tr_b16 v[102:103], v128 offset:16144
    s_barrier
    ds_read_b128 v[112:115], v134 offset:32768
    ds_read_b128 v[116:119], v134 offset:34816
    v_mfma_f32_16x16x32_bf16 v[28:31], v[80:83], v[120:123], v[28:31]
    ds_read_b64_tr_b16 v[104:105], v128 offset:14360
    ds_read_b64_tr_b16 v[106:107], v128 offset:16152
    v_mfma_f32_16x16x32_bf16 v[32:35], v[84:87], v[120:123], v[32:35]
    ds_read_b64_tr_b16 v[108:109], v128 offset:14368
    ds_read_b64_tr_b16 v[110:111], v128 offset:16160
    s_waitcnt lgkmcnt(8)
    v_mfma_f32_16x16x32_bf16 v[36:39], v[88:91], v[120:123], v[36:39]
    ds_read_b64_tr_b16 v[80:81], v128 offset:28816
    ds_read_b64_tr_b16 v[82:83], v128 offset:30608
    v_mfma_f32_16x16x32_bf16 v[40:43], v[92:95], v[120:123], v[40:43]
    ds_read_b64_tr_b16 v[84:85], v128 offset:28824
    ds_read_b64_tr_b16 v[86:87], v128 offset:30616
    v_mfma_f32_16x16x32_bf16 v[64:67], v[120:123], v[96:99], v[64:67]
    v_mfma_f32_16x16x32_bf16 v[68:71], v[124:127], v[96:99], v[68:71]
    ds_read_b64_tr_b16 v[88:89], v128 offset:28832
    ds_read_b64_tr_b16 v[90:91], v128 offset:30624
    s_waitcnt lgkmcnt(6)
    v_mfma_f32_16x16x32_bf16 v[44:47], v[100:103], v[120:123], v[44:47]
    ds_read_b64_tr_b16 v[92:93], v129 offset:28672
    ds_read_b64_tr_b16 v[94:95], v129 offset:30464
    v_mfma_f32_16x16x32_bf16 v[48:51], v[104:107], v[120:123], v[48:51]
    ds_read_b64_tr_b16 v[96:97], v128 offset:28840
    ds_read_b64_tr_b16 v[98:99], v128 offset:30632
    v_mfma_f32_16x16x32_bf16 v[52:55], v[108:111], v[120:123], v[52:55]
    ds_read_b64_tr_b16 v[100:101], v128 offset:28848
    ds_read_b64_tr_b16 v[102:103], v128 offset:30640
    s_waitcnt lgkmcnt(6)
    v_mfma_f32_16x16x32_bf16 v[16:19], v[80:83], v[112:115], v[16:19]
    ds_read_b64_tr_b16 v[104:105], v128 offset:28672
    ds_read_b64_tr_b16 v[106:107], v128 offset:30464
    v_mfma_f32_16x16x32_bf16 v[20:23], v[84:87], v[112:115], v[20:23]
    ds_read_b64_tr_b16 v[108:109], v128 offset:28680
    ds_read_b64_tr_b16 v[110:111], v128 offset:30472
    v_mfma_f32_16x16x32_bf16 v[24:27], v[88:91], v[112:115], v[24:27]
    ds_read_b64_tr_b16 v[80:81], v130 offset:28672
    ds_read_b64_tr_b16 v[82:83], v130 offset:30464
    s_waitcnt lgkmcnt(6)
    v_mfma_f32_16x16x32_bf16 v[56:59], v[112:115], v[92:95], v[56:59]
    v_mfma_f32_16x16x32_bf16 v[60:63], v[116:119], v[92:95], v[60:63]
    ds_read_b64_tr_b16 v[84:85], v128 offset:28688
    ds_read_b64_tr_b16 v[86:87], v128 offset:30480
    s_barrier
    ds_read_b128 v[120:123], v135 offset:32768
    ds_read_b128 v[124:127], v135 offset:34816
    v_mfma_f32_16x16x32_bf16 v[28:31], v[96:99], v[112:115], v[28:31]
    ds_read_b64_tr_b16 v[88:89], v128 offset:28696
    ds_read_b64_tr_b16 v[90:91], v128 offset:30488
    v_mfma_f32_16x16x32_bf16 v[32:35], v[100:103], v[112:115], v[32:35]
    ds_read_b64_tr_b16 v[92:93], v128 offset:28704
    ds_read_b64_tr_b16 v[94:95], v128 offset:30496
    s_waitcnt lgkmcnt(8)
    v_mfma_f32_16x16x32_bf16 v[36:39], v[104:107], v[112:115], v[36:39]
    ds_read_b64_tr_b16 v[96:97], v128 offset:43152
    ds_read_b64_tr_b16 v[98:99], v128 offset:44944
    v_mfma_f32_16x16x32_bf16 v[40:43], v[108:111], v[112:115], v[40:43]
    ds_read_b64_tr_b16 v[100:101], v128 offset:43160
    ds_read_b64_tr_b16 v[102:103], v128 offset:44952
    v_mfma_f32_16x16x32_bf16 v[64:67], v[112:115], v[80:83], v[64:67]
    v_mfma_f32_16x16x32_bf16 v[68:71], v[116:119], v[80:83], v[68:71]
    ds_read_b64_tr_b16 v[104:105], v128 offset:43168
    ds_read_b64_tr_b16 v[106:107], v128 offset:44960
    s_waitcnt lgkmcnt(6)
    v_mfma_f32_16x16x32_bf16 v[44:47], v[84:87], v[112:115], v[44:47]
    ds_read_b64_tr_b16 v[108:109], v129 offset:43008
    ds_read_b64_tr_b16 v[110:111], v129 offset:44800
    v_mfma_f32_16x16x32_bf16 v[48:51], v[88:91], v[112:115], v[48:51]
    ds_read_b64_tr_b16 v[80:81], v128 offset:43176
    ds_read_b64_tr_b16 v[82:83], v128 offset:44968
    v_mfma_f32_16x16x32_bf16 v[52:55], v[92:95], v[112:115], v[52:55]
    ds_read_b64_tr_b16 v[84:85], v128 offset:43184
    ds_read_b64_tr_b16 v[86:87], v128 offset:44976
    s_waitcnt lgkmcnt(6)
    v_mfma_f32_16x16x32_bf16 v[16:19], v[96:99], v[120:123], v[16:19]
    ds_read_b64_tr_b16 v[88:89], v128 offset:43008
    ds_read_b64_tr_b16 v[90:91], v128 offset:44800
    v_mfma_f32_16x16x32_bf16 v[20:23], v[100:103], v[120:123], v[20:23]
    ds_read_b64_tr_b16 v[92:93], v128 offset:43016
    ds_read_b64_tr_b16 v[94:95], v128 offset:44808
    v_mfma_f32_16x16x32_bf16 v[24:27], v[104:107], v[120:123], v[24:27]
    ds_read_b64_tr_b16 v[96:97], v130 offset:43008
    ds_read_b64_tr_b16 v[98:99], v130 offset:44800
    s_waitcnt lgkmcnt(6)
    v_mfma_f32_16x16x32_bf16 v[56:59], v[120:123], v[108:111], v[56:59]
    v_mfma_f32_16x16x32_bf16 v[60:63], v[124:127], v[108:111], v[60:63]
    ds_read_b64_tr_b16 v[100:101], v128 offset:43024
    ds_read_b64_tr_b16 v[102:103], v128 offset:44816
    v_mfma_f32_16x16x32_bf16 v[28:31], v[80:83], v[120:123], v[28:31]
    ds_read_b64_tr_b16 v[104:105], v128 offset:43032
    ds_read_b64_tr_b16 v[106:107], v128 offset:44824
    v_mfma_f32_16x16x32_bf16 v[32:35], v[84:87], v[120:123], v[32:35]
    ds_read_b64_tr_b16 v[108:109], v128 offset:43040
    ds_read_b64_tr_b16 v[110:111], v128 offset:44832
    s_waitcnt lgkmcnt(6)
    v_mfma_f32_16x16x32_bf16 v[36:39], v[88:91], v[120:123], v[36:39]
    v_mfma_f32_16x16x32_bf16 v[40:43], v[92:95], v[120:123], v[40:43]
    v_mfma_f32_16x16x32_bf16 v[64:67], v[120:123], v[96:99], v[64:67]
    v_mfma_f32_16x16x32_bf16 v[68:71], v[124:127], v[96:99], v[68:71]
    s_waitcnt lgkmcnt(0)
    v_mfma_f32_16x16x32_bf16 v[44:47], v[100:103], v[120:123], v[44:47]
    v_mfma_f32_16x16x32_bf16 v[48:51], v[104:107], v[120:123], v[48:51]
    v_mfma_f32_16x16x32_bf16 v[52:55], v[108:111], v[120:123], v[52:55]
    v_mov_b32 v122, 0
    v_mov_b32 v123, 0
    v_cvt_pk_bf16_f32 v112, v36, v37
    v_cvt_pk_bf16_f32 v113, v38, v39
    v_cvt_pk_bf16_f32 v114, v40, v41
    v_cvt_pk_bf16_f32 v115, v42, v43
    v_cvt_pk_bf16_f32 v116, v44, v45
    v_cvt_pk_bf16_f32 v117, v46, v47
    v_cvt_pk_bf16_f32 v118, v48, v49
    v_cvt_pk_bf16_f32 v119, v50, v51
    v_cvt_pk_bf16_f32 v120, v52, v53
    v_cvt_pk_bf16_f32 v121, v54, v55
    s_lshl_b32 s87, s61, 2
    ds_read_b128 v[128:131], v6 offset:0
    ds_read_b128 v[132:135], v6 offset:192
    ds_read_b128 v[136:139], v6 offset:384
    ds_read_b128 v[140:143], v6 offset:576
    ds_read_b128 v[144:147], v6 offset:768
    ds_read_b128 v[148:151], v6 offset:64
    ds_read_b128 v[152:155], v6 offset:256
    ds_read_b128 v[156:159], v6 offset:448
    ds_read_b128 v[160:163], v6 offset:640
    ds_read_b128 v[164:167], v6 offset:832
    s_waitcnt lgkmcnt(5)
    v_mfma_f32_16x16x32_bf16 v[92:95], v[128:131], v[112:115], 0
    v_mfma_f32_16x16x32_bf16 v[96:99], v[132:135], v[112:115], 0
    v_mfma_f32_16x16x32_bf16 v[100:103], v[136:139], v[112:115], 0
    v_mfma_f32_16x16x32_bf16 v[104:107], v[140:143], v[112:115], 0
    v_mfma_f32_16x16x32_bf16 v[108:111], v[144:147], v[112:115], 0
    ds_read_b128 v[128:131], v6 offset:128
    ds_read_b128 v[132:135], v6 offset:320
    ds_read_b128 v[136:139], v6 offset:512
    ds_read_b128 v[140:143], v6 offset:704
    ds_read_b128 v[144:147], v6 offset:896
    s_waitcnt lgkmcnt(5)
    v_mfma_f32_16x16x32_bf16 v[92:95], v[148:151], v[116:119], v[92:95]
    v_mfma_f32_16x16x32_bf16 v[96:99], v[152:155], v[116:119], v[96:99]
    v_mfma_f32_16x16x32_bf16 v[100:103], v[156:159], v[116:119], v[100:103]
    v_mfma_f32_16x16x32_bf16 v[104:107], v[160:163], v[116:119], v[104:107]
    v_mfma_f32_16x16x32_bf16 v[108:111], v[164:167], v[116:119], v[108:111]
    s_waitcnt lgkmcnt(0)
    v_mfma_f32_16x16x32_bf16 v[92:95], v[128:131], v[120:123], v[92:95]
    v_mfma_f32_16x16x32_bf16 v[96:99], v[132:135], v[120:123], v[96:99]
    v_mfma_f32_16x16x32_bf16 v[100:103], v[136:139], v[120:123], v[100:103]
    v_mfma_f32_16x16x32_bf16 v[104:107], v[140:143], v[120:123], v[104:107]
    v_mfma_f32_16x16x32_bf16 v[108:111], v[144:147], v[120:123], v[108:111]
    v_mov_b32 v90, 0
    v_mov_b32 v91, 0
    v_cvt_pk_bf16_f32 v80, v16, v17
    v_cvt_pk_bf16_f32 v81, v18, v19
    v_cvt_pk_bf16_f32 v82, v20, v21
    v_cvt_pk_bf16_f32 v83, v22, v23
    v_cvt_pk_bf16_f32 v84, v24, v25
    v_cvt_pk_bf16_f32 v85, v26, v27
    v_cvt_pk_bf16_f32 v86, v28, v29
    v_cvt_pk_bf16_f32 v87, v30, v31
    v_cvt_pk_bf16_f32 v88, v32, v33
    v_cvt_pk_bf16_f32 v89, v34, v35
    v_lshl_add_u32 v10, v2, 12, v3
    v_lshlrev_b32 v126, 4, v10
    v_lshl_add_u32 v10, v2, 11, v3
    v_lshlrev_b32 v127, 2, v10
    s_lshl_b32 s88, s87, 12
    s_add_u32 s88, s88, s68
    s_lshl_b32 s88, s88, 4
    s_add_u32 s89, s88, 32768
    s_lshl_b32 s90, s87, 11
    s_add_u32 s90, s90, s68
    s_lshl_b32 s90, s90, 2
    s_add_u32 s90, s90, 0x400000
    v_cvt_pk_bf16_f32 v36, v92, v93
    v_cvt_pk_bf16_f32 v37, v94, v95
    v_cvt_pk_bf16_f32 v38, v96, v97
    v_cvt_pk_bf16_f32 v39, v98, v99
    v_cvt_pk_bf16_f32 v40, v100, v101
    v_cvt_pk_bf16_f32 v41, v102, v103
    v_cvt_pk_bf16_f32 v42, v104, v105
    v_cvt_pk_bf16_f32 v43, v106, v107
    v_cvt_pk_bf16_f32 v44, v108, v109
    buffer_store_dwordx4 v[36:39], v126, s[16:19], s88 offen offset:0 sc1
    buffer_store_dwordx4 v[40:43], v126, s[16:19], s89 offen offset:0 sc1
    buffer_store_dword v44, v127, s[16:19], s90 offen offset:0 sc1
    ds_read_b128 v[128:131], v6 offset:0
    ds_read_b128 v[132:135], v6 offset:192
    ds_read_b128 v[136:139], v6 offset:384
    ds_read_b128 v[140:143], v6 offset:576
    ds_read_b128 v[144:147], v6 offset:768
    ds_read_b128 v[148:151], v6 offset:64
    ds_read_b128 v[152:155], v6 offset:256
    ds_read_b128 v[156:159], v6 offset:448
    ds_read_b128 v[160:163], v6 offset:640
    ds_read_b128 v[164:167], v6 offset:832
    s_waitcnt lgkmcnt(5)
    v_mfma_f32_16x16x32_bf16 v[92:95], v[128:131], v[80:83], 0
    v_mfma_f32_16x16x32_bf16 v[96:99], v[132:135], v[80:83], 0
    v_mfma_f32_16x16x32_bf16 v[100:103], v[136:139], v[80:83], 0
    v_mfma_f32_16x16x32_bf16 v[104:107], v[140:143], v[80:83], 0
    v_mfma_f32_16x16x32_bf16 v[108:111], v[144:147], v[80:83], 0
    ds_read_b128 v[128:131], v6 offset:128
    ds_read_b128 v[132:135], v6 offset:320
    ds_read_b128 v[136:139], v6 offset:512
    ds_read_b128 v[140:143], v6 offset:704
    ds_read_b128 v[144:147], v6 offset:896
    s_waitcnt lgkmcnt(5)
    v_mfma_f32_16x16x32_bf16 v[92:95], v[148:151], v[84:87], v[92:95]
    v_mfma_f32_16x16x32_bf16 v[96:99], v[152:155], v[84:87], v[96:99]
    v_mfma_f32_16x16x32_bf16 v[100:103], v[156:159], v[84:87], v[100:103]
    v_mfma_f32_16x16x32_bf16 v[104:107], v[160:163], v[84:87], v[104:107]
    v_mfma_f32_16x16x32_bf16 v[108:111], v[164:167], v[84:87], v[108:111]
    s_waitcnt lgkmcnt(0)
    v_mfma_f32_16x16x32_bf16 v[92:95], v[128:131], v[88:91], v[92:95]
    v_mfma_f32_16x16x32_bf16 v[96:99], v[132:135], v[88:91], v[96:99]
    v_mfma_f32_16x16x32_bf16 v[100:103], v[136:139], v[88:91], v[100:103]
    v_mfma_f32_16x16x32_bf16 v[104:107], v[140:143], v[88:91], v[104:107]
    v_mfma_f32_16x16x32_bf16 v[108:111], v[144:147], v[88:91], v[108:111]
    s_lshl_b32 s87, s61, 2
    s_lshl_b32 s67, s94, 5
    s_add_u32 s67, s67, 0
    v_add_u32 v12, s67, v3
    v_mul_u32_u24 v12, 296, v12
    v_mul_u32_u24 v13, 72, v2
    v_add_u32 v124, v12, v13
    v_add_u32 v124, 57344, v124
    v_max3_f32 v146, v92, v93, v94
    v_min3_f32 v148, v92, v93, v94
    v_max3_f32 v146, v146, v95, v96
    v_min3_f32 v148, v148, v95, v96
    v_max3_f32 v146, v146, v97, v98
    v_min3_f32 v148, v148, v97, v98
    v_max3_f32 v146, v146, v99, v100
    v_min3_f32 v148, v148, v99, v100
    v_max3_f32 v146, v146, v101, v102
    v_min3_f32 v148, v148, v101, v102
    v_max3_f32 v146, v146, v103, v104
    v_min3_f32 v148, v148, v103, v104
    v_max3_f32 v146, v146, v105, v106
    v_min3_f32 v148, v148, v105, v106
    v_max3_f32 v146, v146, v107, v108
    v_min3_f32 v148, v148, v107, v108
    v_max_f32 v146, v146, v109
    v_min_f32 v148, v148, v109
    v_mul_f32 v146, s72, v146
    v_mul_f32 v148, s72, v148
    v_pk_fma_f32 v[16:17], v[92:93], s[72:73], v[146:147] op_sel_hi:[1,1,0] neg_lo:[0,0,1] neg_hi:[0,0,1]
    v_pk_fma_f32 v[128:129], v[92:93], s[72:73], v[148:149] op_sel_hi:[1,1,0] neg_lo:[1,0,0] neg_hi:[1,0,0]
    v_pk_fma_f32 v[18:19], v[94:95], s[72:73], v[146:147] op_sel_hi:[1,1,0] neg_lo:[0,0,1] neg_hi:[0,0,1]
    v_pk_fma_f32 v[130:131], v[94:95], s[72:73], v[148:149] op_sel_hi:[1,1,0] neg_lo:[1,0,0] neg_hi:[1,0,0]
    v_pk_fma_f32 v[20:21], v[96:97], s[72:73], v[146:147] op_sel_hi:[1,1,0] neg_lo:[0,0,1] neg_hi:[0,0,1]
    v_pk_fma_f32 v[132:133], v[96:97], s[72:73], v[148:149] op_sel_hi:[1,1,0] neg_lo:[1,0,0] neg_hi:[1,0,0]
    v_pk_fma_f32 v[22:23], v[98:99], s[72:73], v[146:147] op_sel_hi:[1,1,0] neg_lo:[0,0,1] neg_hi:[0,0,1]
    v_pk_fma_f32 v[134:135], v[98:99], s[72:73], v[148:149] op_sel_hi:[1,1,0] neg_lo:[1,0,0] neg_hi:[1,0,0]
    v_pk_fma_f32 v[24:25], v[100:101], s[72:73], v[146:147] op_sel_hi:[1,1,0] neg_lo:[0,0,1] neg_hi:[0,0,1]
    v_pk_fma_f32 v[136:137], v[100:101], s[72:73], v[148:149] op_sel_hi:[1,1,0] neg_lo:[1,0,0] neg_hi:[1,0,0]
    v_pk_fma_f32 v[26:27], v[102:103], s[72:73], v[146:147] op_sel_hi:[1,1,0] neg_lo:[0,0,1] neg_hi:[0,0,1]
    v_pk_fma_f32 v[138:139], v[102:103], s[72:73], v[148:149] op_sel_hi:[1,1,0] neg_lo:[1,0,0] neg_hi:[1,0,0]
    v_pk_fma_f32 v[28:29], v[104:105], s[72:73], v[146:147] op_sel_hi:[1,1,0] neg_lo:[0,0,1] neg_hi:[0,0,1]
    v_pk_fma_f32 v[140:141], v[104:105], s[72:73], v[148:149] op_sel_hi:[1,1,0] neg_lo:[1,0,0] neg_hi:[1,0,0]
    v_pk_fma_f32 v[30:31], v[106:107], s[72:73], v[146:147] op_sel_hi:[1,1,0] neg_lo:[0,0,1] neg_hi:[0,0,1]
    v_pk_fma_f32 v[142:143], v[106:107], s[72:73], v[148:149] op_sel_hi:[1,1,0] neg_lo:[1,0,0] neg_hi:[1,0,0]
    v_pk_fma_f32 v[32:33], v[108:109], s[72:73], v[146:147] op_sel_hi:[1,1,0] neg_lo:[0,0,1] neg_hi:[0,0,1]
    v_pk_fma_f32 v[144:145], v[108:109], s[72:73], v[148:149] op_sel_hi:[1,1,0] neg_lo:[1,0,0] neg_hi:[1,0,0]
    v_exp_f32 v16, v16
    v_exp_f32 v128, v128
    v_exp_f32 v17, v17
    v_exp_f32 v129, v129
    v_exp_f32 v18, v18
    v_exp_f32 v130, v130
    v_exp_f32 v19, v19
    v_exp_f32 v131, v131
    v_exp_f32 v20, v20
    v_exp_f32 v132, v132
    v_exp_f32 v21, v21
    v_exp_f32 v133, v133
    v_exp_f32 v22, v22
    v_exp_f32 v134, v134
    v_exp_f32 v23, v23
    v_exp_f32 v135, v135
    v_exp_f32 v24, v24
    v_exp_f32 v136, v136
    v_exp_f32 v25, v25
    v_exp_f32 v137, v137
    v_exp_f32 v26, v26
    v_exp_f32 v138, v138
    v_exp_f32 v27, v27
    v_exp_f32 v139, v139
    v_exp_f32 v28, v28
    v_exp_f32 v140, v140
    v_exp_f32 v29, v29
    v_exp_f32 v141, v141
    v_exp_f32 v30, v30
    v_exp_f32 v142, v142
    v_exp_f32 v31, v31
    v_exp_f32 v143, v143
    v_exp_f32 v32, v32
    v_exp_f32 v144, v144
    v_exp_f32 v33, v33
    v_exp_f32 v145, v145
    v_pk_add_f32 v[150:151], v[16:17], v[18:19]
    v_pk_add_f32 v[150:151], v[150:151], v[20:21]
    v_pk_add_f32 v[150:151], v[150:151], v[22:23]
    v_pk_add_f32 v[150:151], v[150:151], v[24:25]
    v_pk_add_f32 v[150:151], v[150:151], v[26:27]
    v_pk_add_f32 v[150:151], v[150:151], v[28:29]
    v_pk_add_f32 v[150:151], v[150:151], v[30:31]
    v_pk_add_f32 v[150:151], v[150:151], v[32:33]
    v_add_f32 v150, v150, v151
    v_rcp_f32 v150, v150
    s_nop 0
    v_pk_mul_f32 v[16:17], v[16:17], v[150:151] op_sel_hi:[1,0]
    v_pk_mul_f32 v[18:19], v[18:19], v[150:151] op_sel_hi:[1,0]
    v_pk_mul_f32 v[20:21], v[20:21], v[150:151] op_sel_hi:[1,0]
    v_pk_mul_f32 v[22:23], v[22:23], v[150:151] op_sel_hi:[1,0]
    v_pk_mul_f32 v[24:25], v[24:25], v[150:151] op_sel_hi:[1,0]
    v_pk_mul_f32 v[26:27], v[26:27], v[150:151] op_sel_hi:[1,0]
    v_pk_mul_f32 v[28:29], v[28:29], v[150:151] op_sel_hi:[1,0]
    v_pk_mul_f32 v[30:31], v[30:31], v[150:151] op_sel_hi:[1,0]
    v_pk_mul_f32 v[32:33], v[32:33], v[150:151] op_sel_hi:[1,0]
    v_pk_add_f32 v[150:151], v[128:129], v[130:131]
    v_pk_add_f32 v[150:151], v[150:151], v[132:133]
    v_pk_add_f32 v[150:151], v[150:151], v[134:135]
    v_pk_add_f32 v[150:151], v[150:151], v[136:137]
    v_pk_add_f32 v[150:151], v[150:151], v[138:139]
    v_pk_add_f32 v[150:151], v[150:151], v[140:141]
    v_pk_add_f32 v[150:151], v[150:151], v[142:143]
    v_pk_add_f32 v[150:151], v[150:151], v[144:145]
    v_add_f32 v150, v150, v151
    v_rcp_f32 v150, v150
    s_nop 0
    v_pk_mul_f32 v[128:129], v[128:129], v[150:151] op_sel_hi:[1,0]
    v_pk_mul_f32 v[130:131], v[130:131], v[150:151] op_sel_hi:[1,0]
    v_pk_mul_f32 v[132:133], v[132:133], v[150:151] op_sel_hi:[1,0]
    v_pk_mul_f32 v[134:135], v[134:135], v[150:151] op_sel_hi:[1,0]
    v_pk_mul_f32 v[136:137], v[136:137], v[150:151] op_sel_hi:[1,0]
    v_pk_mul_f32 v[138:139], v[138:139], v[150:151] op_sel_hi:[1,0]
    v_pk_mul_f32 v[140:141], v[140:141], v[150:151] op_sel_hi:[1,0]
    v_pk_mul_f32 v[142:143], v[142:143], v[150:151] op_sel_hi:[1,0]
    v_pk_mul_f32 v[144:145], v[144:145], v[150:151] op_sel_hi:[1,0]
    v_cvt_pk_bf16_f32 v92, v16, v17
    v_cvt_pk_bf16_f32 v101, v128, v129
    v_cvt_pk_bf16_f32 v93, v18, v19
    v_cvt_pk_bf16_f32 v102, v130, v131
    v_cvt_pk_bf16_f32 v94, v20, v21
    v_cvt_pk_bf16_f32 v103, v132, v133
    v_cvt_pk_bf16_f32 v95, v22, v23
    v_cvt_pk_bf16_f32 v104, v134, v135
    v_cvt_pk_bf16_f32 v96, v24, v25
    v_cvt_pk_bf16_f32 v105, v136, v137
    v_cvt_pk_bf16_f32 v97, v26, v27
    v_cvt_pk_bf16_f32 v106, v138, v139
    v_cvt_pk_bf16_f32 v98, v28, v29
    v_cvt_pk_bf16_f32 v107, v140, v141
    v_cvt_pk_bf16_f32 v99, v30, v31
    v_cvt_pk_bf16_f32 v108, v142, v143
    v_cvt_pk_bf16_f32 v100, v32, v33
    v_cvt_pk_bf16_f32 v109, v144, v145
    ds_write_b64 v124, v[92:93] offset:0
    ds_write_b64 v124, v[94:95] offset:8
    ds_write_b64 v124, v[96:97] offset:16
    ds_write_b64 v124, v[98:99] offset:24
    ds_write_b64 v124, v[100:101] offset:32
    ds_write_b64 v124, v[102:103] offset:40
    ds_write_b64 v124, v[104:105] offset:48
    ds_write_b64 v124, v[106:107] offset:56
    ds_write_b64 v124, v[108:109] offset:64
    s_mul_i32 s67, s94, 5120
    s_add_u32 s67, s67, 100352
    v_lshl_add_u32 v125, v1, 4, s67
    v_cvt_pk_bf16_f32 v152, v56, v57
    v_cvt_pk_bf16_f32 v153, v58, v59
    v_cvt_pk_bf16_f32 v154, v60, v61
    v_cvt_pk_bf16_f32 v155, v62, v63
    v_cmp_lt_u32 vcc, 7, v3
    v_mov_b32 v12, 0x3f803f80
    s_nop 0
    v_cndmask_b32 v152, v152, v12, vcc
    v_cndmask_b32 v153, v153, v12, vcc
    v_cndmask_b32 v154, v154, v12, vcc
    v_cndmask_b32 v155, v155, v12, vcc
    ds_write_b128 v125, v[152:155] offset:4096
    v_cvt_pk_bf16_f32 v156, v64, v65
    v_cvt_pk_bf16_f32 v157, v66, v67
    v_cvt_pk_bf16_f32 v158, v68, v69
    v_cvt_pk_bf16_f32 v159, v70, v71
    ds_write_b128 v125, v[156:159] offset:0
    s_waitcnt lgkmcnt(0)
    s_barrier
    v_lshl_add_u32 v12, v2, 2, v4
    v_mul_u32_u24 v12, 296, v12
    v_lshl_add_u32 v12, v5, 3, v12
    s_mul_i32 s67, s94, 72
    s_add_u32 s67, s67, 57344
    v_add_u32 v124, s67, v12
    s_lshl_b32 s67, s94, 10
    s_add_u32 s67, s67, 100352
    v_lshl_add_u32 v125, v1, 4, s67
    ds_read_b64_tr_b16 v[28:29], v124 offset:0
    ds_read_b64_tr_b16 v[30:31], v124 offset:4736
    ds_read_b64_tr_b16 v[32:33], v124 offset:32
    ds_read_b64_tr_b16 v[34:35], v124 offset:4768
    ds_read_b64_tr_b16 v[36:37], v124 offset:64
    ds_read_b64_tr_b16 v[38:39], v124 offset:4800
    ds_read_b128 v[76:79], v125 offset:0
    ds_read_b64_tr_b16 v[40:41], v124 offset:9472
    ds_read_b64_tr_b16 v[42:43], v124 offset:14208
    ds_read_b64_tr_b16 v[44:45], v124 offset:9504
    ds_read_b64_tr_b16 v[46:47], v124 offset:14240
    ds_read_b64_tr_b16 v[48:49], v124 offset:9536
    ds_read_b64_tr_b16 v[50:51], v124 offset:14272
    ds_read_b128 v[80:83], v125 offset:5120
    s_waitcnt lgkmcnt(7)
    v_mfma_f32_16x16x32_bf16 v[16:19], v[28:31], v[76:79], 0
    v_mfma_f32_16x16x32_bf16 v[20:23], v[32:35], v[76:79], 0
    v_mfma_f32_16x16x32_bf16 v[24:27], v[36:39], v[76:79], 0
    ds_read_b64_tr_b16 v[52:53], v124 offset:18944
    ds_read_b64_tr_b16 v[54:55], v124 offset:23680
    ds_read_b64_tr_b16 v[56:57], v124 offset:18976
    ds_read_b64_tr_b16 v[58:59], v124 offset:23712
    ds_read_b64_tr_b16 v[60:61], v124 offset:19008
    ds_read_b64_tr_b16 v[62:63], v124 offset:23744
    ds_read_b128 v[84:87], v125 offset:10240
    s_waitcnt lgkmcnt(7)
    v_mfma_f32_16x16x32_bf16 v[16:19], v[40:43], v[80:83], v[16:19]
    v_mfma_f32_16x16x32_bf16 v[20:23], v[44:47], v[80:83], v[20:23]
    v_mfma_f32_16x16x32_bf16 v[24:27], v[48:51], v[80:83], v[24:27]
    ds_read_b64_tr_b16 v[64:65], v124 offset:28416
    ds_read_b64_tr_b16 v[66:67], v124 offset:33152
    ds_read_b64_tr_b16 v[68:69], v124 offset:28448
    ds_read_b64_tr_b16 v[70:71], v124 offset:33184
    ds_read_b64_tr_b16 v[72:73], v124 offset:28480
    ds_read_b64_tr_b16 v[74:75], v124 offset:33216
    ds_read_b128 v[88:91], v125 offset:15360
    s_waitcnt lgkmcnt(7)
    v_mfma_f32_16x16x32_bf16 v[16:19], v[52:55], v[84:87], v[16:19]
    v_mfma_f32_16x16x32_bf16 v[20:23], v[56:59], v[84:87], v[20:23]
    v_mfma_f32_16x16x32_bf16 v[24:27], v[60:63], v[84:87], v[24:27]
    s_and_b32 s85, s94, 1
    s_lshl_b32 s85, s85, 1
    v_mul_u32_u24 v12, 20, v2
    v_mov_b32 v14, s75
    v_add3_u32 v13, v12, v3, s85
    v_lshlrev_b32 v126, 4, v13
    v_cmp_eq_u32 vcc, 0, v2
    s_nop 1
    v_cndmask_b32 v127, v14, v126, vcc
    s_add_u32 s67, s87, s94
    s_lshl_b32 s67, s67, 4
    s_add_u32 s67, s67, s60
    s_mul_i32 s67, s67, 3072
    s_add_u32 s67, s67, 0x500000
    s_waitcnt lgkmcnt(0)
    v_mfma_f32_16x16x32_bf16 v[16:19], v[64:67], v[88:91], v[16:19]
    v_mfma_f32_16x16x32_bf16 v[20:23], v[68:71], v[88:91], v[20:23]
    v_mfma_f32_16x16x32_bf16 v[24:27], v[72:75], v[88:91], v[24:27]
    s_nop 5
    buffer_store_dwordx4 v[16:19], v126, s[16:19], s67 offen offset:0 sc1
    buffer_store_dwordx4 v[20:23], v126, s[16:19], s67 offen offset:1280 sc1
    buffer_store_dwordx4 v[24:27], v127, s[16:19], s67 offen offset:2560 sc1
    s_endpgm
K1_ROLE1:
    s_mov_b32 s67, 0x40282008
    v_lshrrev_b32 v10, v9, s67
    v_and_b32 v10, 0xff, v10
    v_add_u32 v129, v10, v8
    v_add_u32 v129, 288, v129
    v_add_u32 v132, 57344, v129
    s_mov_b32 s67, 0x38301810
    v_lshrrev_b32 v10, v9, s67
    v_and_b32 v10, 0xff, v10
    v_add_u32 v130, v10, v8
    v_add_u32 v130, 288, v130
    v_add_u32 v133, 57344, v130
    s_barrier
    ds_read_b128 v[112:115], v134 offset:0
    ds_read_b128 v[116:119], v134 offset:2048
    ds_read_b64_tr_b16 v[80:81], v128 offset:144
    ds_read_b64_tr_b16 v[82:83], v128 offset:1936
    ds_read_b64_tr_b16 v[84:85], v128 offset:152
    ds_read_b64_tr_b16 v[86:87], v128 offset:1944
    ds_read_b64_tr_b16 v[88:89], v128 offset:160
    ds_read_b64_tr_b16 v[90:91], v128 offset:1952
    ds_read_b64_tr_b16 v[92:93], v129 offset:0
    ds_read_b64_tr_b16 v[94:95], v129 offset:1792
    ds_read_b64_tr_b16 v[96:97], v128 offset:168
    ds_read_b64_tr_b16 v[98:99], v128 offset:1960
    ds_read_b64_tr_b16 v[100:101], v128 offset:176
    ds_read_b64_tr_b16 v[102:103], v128 offset:1968
    s_waitcnt lgkmcnt(12)
    s_waitcnt lgkmcnt(6)
    v_mfma_f32_16x16x32_bf16 v[16:19], v[80:83], v[116:119], 0
    ds_read_b64_tr_b16 v[104:105], v128 offset:0
    ds_read_b64_tr_b16 v[106:107], v128 offset:1792
    v_mfma_f32_16x16x32_bf16 v[20:23], v[84:87], v[116:119], 0
    ds_read_b64_tr_b16 v[108:109], v128 offset:8
    ds_read_b64_tr_b16 v[110:111], v128 offset:1800
    v_mfma_f32_16x16x32_bf16 v[24:27], v[88:91], v[116:119], 0
    ds_read_b64_tr_b16 v[80:81], v129 offset:64
    ds_read_b64_tr_b16 v[82:83], v129 offset:1856
    s_waitcnt lgkmcnt(6)
    v_mfma_f32_16x16x32_bf16 v[56:59], v[112:115], v[92:95], 0
    v_mfma_f32_16x16x32_bf16 v[60:63], v[116:119], v[92:95], 0
    ds_read_b64_tr_b16 v[84:85], v128 offset:16
    ds_read_b64_tr_b16 v[86:87], v128 offset:1808
    s_barrier
    ds_read_b128 v[120:123], v135 offset:0
    ds_read_b128 v[124:127], v135 offset:2048
    v_mfma_f32_16x16x32_bf16 v[28:31], v[96:99], v[116:119], 0
    ds_read_b64_tr_b16 v[88:89], v128 offset:24
    ds_read_b64_tr_b16 v[90:91], v128 offset:1816
    v_mfma_f32_16x16x32_bf16 v[32:35], v[100:103], v[116:119], 0
    ds_read_b64_tr_b16 v[92:93], v128 offset:32
    ds_read_b64_tr_b16 v[94:95], v128 offset:1824
    s_waitcnt lgkmcnt(8)
    v_mfma_f32_16x16x32_bf16 v[36:39], v[104:107], v[116:119], 0
    ds_read_b64_tr_b16 v[96:97], v130 offset:64
    ds_read_b64_tr_b16 v[98:99], v130 offset:1856
    v_mfma_f32_16x16x32_bf16 v[40:43], v[108:111], v[116:119], 0
    ds_read_b64_tr_b16 v[100:101], v128 offset:14480
    ds_read_b64_tr_b16 v[102:103], v128 offset:16272
    v_mfma_f32_16x16x32_bf16 v[64:67], v[112:115], v[80:83], 0
    v_mfma_f32_16x16x32_bf16 v[68:71], v[116:119], v[80:83], 0
    ds_read_b64_tr_b16 v[104:105], v128 offset:14488
    ds_read_b64_tr_b16 v[106:107], v128 offset:16280
    s_waitcnt lgkmcnt(6)
    v_mfma_f32_16x16x32_bf16 v[44:47], v[84:87], v[116:119], 0
    ds_read_b64_tr_b16 v[108:109], v128 offset:14496
    ds_read_b64_tr_b16 v[110:111], v128 offset:16288
    v_mfma_f32_16x16x32_bf16 v[48:51], v[88:91], v[116:119], 0
    ds_read_b64_tr_b16 v[80:81], v129 offset:14336
    ds_read_b64_tr_b16 v[82:83], v129 offset:16128
    v_mfma_f32_16x16x32_bf16 v[52:55], v[92:95], v[116:119], 0
    ds_read_b64_tr_b16 v[84:85], v128 offset:14504
    ds_read_b64_tr_b16 v[86:87], v128 offset:16296
    s_waitcnt lgkmcnt(6)
    v_mfma_f32_16x16x32_bf16 v[72:75], v[112:115], v[96:99], 0
    v_mfma_f32_16x16x32_bf16 v[76:79], v[116:119], v[96:99], 0
    ds_read_b64_tr_b16 v[88:89], v128 offset:14512
    ds_read_b64_tr_b16 v[90:91], v128 offset:16304
    v_mfma_f32_16x16x32_bf16 v[16:19], v[100:103], v[124:127], v[16:19]
    ds_read_b64_tr_b16 v[92:93], v128 offset:14336
    ds_read_b64_tr_b16 v[94:95], v128 offset:16128
    v_mfma_f32_16x16x32_bf16 v[20:23], v[104:107], v[124:127], v[20:23]
    ds_read_b64_tr_b16 v[96:97], v128 offset:14344
    ds_read_b64_tr_b16 v[98:99], v128 offset:16136
    s_waitcnt lgkmcnt(6)
    v_mfma_f32_16x16x32_bf16 v[24:27], v[108:111], v[124:127], v[24:27]
    ds_read_b64_tr_b16 v[100:101], v129 offset:14400
    ds_read_b64_tr_b16 v[102:103], v129 offset:16192
    v_mfma_f32_16x16x32_bf16 v[56:59], v[120:123], v[80:83], v[56:59]
    v_mfma_f32_16x16x32_bf16 v[60:63], v[124:127], v[80:83], v[60:63]
    ds_read_b64_tr_b16 v[104:105], v128 offset:14352
    ds_read_b64_tr_b16 v[106:107], v128 offset:16144
    s_barrier
    ds_read_b128 v[112:115], v134 offset:16384
    ds_read_b128 v[116:119], v134 offset:18432
    v_mfma_f32_16x16x32_bf16 v[28:31], v[84:87], v[124:127], v[28:31]
    ds_read_b64_tr_b16 v[108:109], v128 offset:14360
    ds_read_b64_tr_b16 v[110:111], v128 offset:16152
    s_waitcnt lgkmcnt(8)
    v_mfma_f32_16x16x32_bf16 v[32:35], v[88:91], v[124:127], v[32:35]
    ds_read_b64_tr_b16 v[80:81], v128 offset:14368
    ds_read_b64_tr_b16 v[82:83], v128 offset:16160
    v_mfma_f32_16x16x32_bf16 v[36:39], v[92:95], v[124:127], v[36:39]
    ds_read_b64_tr_b16 v[84:85], v130 offset:14400
    ds_read_b64_tr_b16 v[86:87], v130 offset:16192
    v_mfma_f32_16x16x32_bf16 v[40:43], v[96:99], v[124:127], v[40:43]
    ds_read_b64_tr_b16 v[88:89], v128 offset:28816
    ds_read_b64_tr_b16 v[90:91], v128 offset:30608
    s_waitcnt lgkmcnt(6)
    v_mfma_f32_16x16x32_bf16 v[64:67], v[120:123], v[100:103], v[64:67]
    v_mfma_f32_16x16x32_bf16 v[68:71], v[124:127], v[100:103], v[68:71]
    ds_read_b64_tr_b16 v[92:93], v128 offset:28824
    ds_read_b64_tr_b16 v[94:95], v128 offset:30616
    v_mfma_f32_16x16x32_bf16 v[44:47], v[104:107], v[124:127], v[44:47]
    ds_read_b64_tr_b16 v[96:97], v128 offset:28832
    ds_read_b64_tr_b16 v[98:99], v128 offset:30624
    v_mfma_f32_16x16x32_bf16 v[48:51], v[108:111], v[124:127], v[48:51]
    ds_read_b64_tr_b16 v[100:101], v129 offset:28672
    ds_read_b64_tr_b16 v[102:103], v129 offset:30464
    s_waitcnt lgkmcnt(6)
    v_mfma_f32_16x16x32_bf16 v[52:55], v[80:83], v[124:127], v[52:55]
    ds_read_b64_tr_b16 v[104:105], v128 offset:28840
    ds_read_b64_tr_b16 v[106:107], v128 offset:30632
    v_mfma_f32_16x16x32_bf16 v[72:75], v[120:123], v[84:87], v[72:75]
    v_mfma_f32_16x16x32_bf16 v[76:79], v[124:127], v[84:87], v[76:79]
    ds_read_b64_tr_b16 v[108:109], v128 offset:28848
    ds_read_b64_tr_b16 v[110:111], v128 offset:30640
    v_mfma_f32_16x16x32_bf16 v[16:19], v[88:91], v[116:119], v[16:19]
    ds_read_b64_tr_b16 v[80:81], v128 offset:28672
    ds_read_b64_tr_b16 v[82:83], v128 offset:30464
    s_waitcnt lgkmcnt(6)
    v_mfma_f32_16x16x32_bf16 v[20:23], v[92:95], v[116:119], v[20:23]
    ds_read_b64_tr_b16 v[84:85], v128 offset:28680
    ds_read_b64_tr_b16 v[86:87], v128 offset:30472
    v_mfma_f32_16x16x32_bf16 v[24:27], v[96:99], v[116:119], v[24:27]
    ds_read_b64_tr_b16 v[88:89], v129 offset:28736
    ds_read_b64_tr_b16 v[90:91], v129 offset:30528
    v_mfma_f32_16x16x32_bf16 v[56:59], v[112:115], v[100:103], v[56:59]
    v_mfma_f32_16x16x32_bf16 v[60:63], v[116:119], v[100:103], v[60:63]
    ds_read_b64_tr_b16 v[92:93], v128 offset:28688
    ds_read_b64_tr_b16 v[94:95], v128 offset:30480
    s_barrier
    ds_read_b128 v[120:123], v135 offset:16384
    ds_read_b128 v[124:127], v135 offset:18432
    s_waitcnt lgkmcnt(8)
    v_mfma_f32_16x16x32_bf16 v[28:31], v[104:107], v[116:119], v[28:31]
    ds_read_b64_tr_b16 v[96:97], v128 offset:28696
    ds_read_b64_tr_b16 v[98:99], v128 offset:30488
    v_mfma_f32_16x16x32_bf16 v[32:35], v[108:111], v[116:119], v[32:35]
    ds_read_b64_tr_b16 v[100:101], v128 offset:28704
    ds_read_b64_tr_b16 v[102:103], v128 offset:30496
    v_mfma_f32_16x16x32_bf16 v[36:39], v[80:83], v[116:119], v[36:39]
    ds_read_b64_tr_b16 v[104:105], v130 offset:28736
    ds_read_b64_tr_b16 v[106:107], v130 offset:30528
    s_waitcnt lgkmcnt(8)
    v_mfma_f32_16x16x32_bf16 v[40:43], v[84:87], v[116:119], v[40:43]
    ds_read_b64_tr_b16 v[108:109], v128 offset:43152
    ds_read_b64_tr_b16 v[110:111], v128 offset:44944
    v_mfma_f32_16x16x32_bf16 v[64:67], v[112:115], v[88:91], v[64:67]
    v_mfma_f32_16x16x32_bf16 v[68:71], v[116:119], v[88:91], v[68:71]
    ds_read_b64_tr_b16 v[80:81], v128 offset:43160
    ds_read_b64_tr_b16 v[82:83], v128 offset:44952
    v_mfma_f32_16x16x32_bf16 v[44:47], v[92:95], v[116:119], v[44:47]
    ds_read_b64_tr_b16 v[84:85], v128 offset:43168
    ds_read_b64_tr_b16 v[86:87], v128 offset:44960
    s_waitcnt lgkmcnt(6)
    v_mfma_f32_16x16x32_bf16 v[48:51], v[96:99], v[116:119], v[48:51]
    ds_read_b64_tr_b16 v[88:89], v129 offset:43008
    ds_read_b64_tr_b16 v[90:91], v129 offset:44800
    v_mfma_f32_16x16x32_bf16 v[52:55], v[100:103], v[116:119], v[52:55]
    ds_read_b64_tr_b16 v[92:93], v128 offset:43176
    ds_read_b64_tr_b16 v[94:95], v128 offset:44968
    v_mfma_f32_16x16x32_bf16 v[72:75], v[112:115], v[104:107], v[72:75]
    v_mfma_f32_16x16x32_bf16 v[76:79], v[116:119], v[104:107], v[76:79]
    ds_read_b64_tr_b16 v[96:97], v128 offset:43184
    ds_read_b64_tr_b16 v[98:99], v128 offset:44976
    s_waitcnt lgkmcnt(6)
    v_mfma_f32_16x16x32_bf16 v[16:19], v[108:111], v[124:127], v[16:19]
    ds_read_b64_tr_b16 v[100:101], v128 offset:43008
    ds_read_b64_tr_b16 v[102:103], v128 offset:44800
    v_mfma_f32_16x16x32_bf16 v[20:23], v[80:83], v[124:127], v[20:23]
    ds_read_b64_tr_b16 v[104:105], v128 offset:43016
    ds_read_b64_tr_b16 v[106:107], v128 offset:44808
    v_mfma_f32_16x16x32_bf16 v[24:27], v[84:87], v[124:127], v[24:27]
    ds_read_b64_tr_b16 v[108:109], v129 offset:43072
    ds_read_b64_tr_b16 v[110:111], v129 offset:44864
    s_waitcnt lgkmcnt(6)
    v_mfma_f32_16x16x32_bf16 v[56:59], v[120:123], v[88:91], v[56:59]
    v_mfma_f32_16x16x32_bf16 v[60:63], v[124:127], v[88:91], v[60:63]
    ds_read_b64_tr_b16 v[80:81], v128 offset:43024
    ds_read_b64_tr_b16 v[82:83], v128 offset:44816
    s_barrier
    ds_read_b128 v[112:115], v134 offset:32768
    ds_read_b128 v[116:119], v134 offset:34816
    v_mfma_f32_16x16x32_bf16 v[28:31], v[92:95], v[124:127], v[28:31]
    ds_read_b64_tr_b16 v[84:85], v128 offset:43032
    ds_read_b64_tr_b16 v[86:87], v128 offset:44824
    v_mfma_f32_16x16x32_bf16 v[32:35], v[96:99], v[124:127], v[32:35]
    ds_read_b64_tr_b16 v[88:89], v128 offset:43040
    ds_read_b64_tr_b16 v[90:91], v128 offset:44832
    s_waitcnt lgkmcnt(8)
    v_mfma_f32_16x16x32_bf16 v[36:39], v[100:103], v[124:127], v[36:39]
    ds_read_b64_tr_b16 v[92:93], v130 offset:43072
    ds_read_b64_tr_b16 v[94:95], v130 offset:44864
    v_mfma_f32_16x16x32_bf16 v[40:43], v[104:107], v[124:127], v[40:43]
    ds_read_b64_tr_b16 v[96:97], v131 offset:144
    ds_read_b64_tr_b16 v[98:99], v131 offset:1936
    v_mfma_f32_16x16x32_bf16 v[64:67], v[120:123], v[108:111], v[64:67]
    v_mfma_f32_16x16x32_bf16 v[68:71], v[124:127], v[108:111], v[68:71]
    ds_read_b64_tr_b16 v[100:101], v131 offset:152
    ds_read_b64_tr_b16 v[102:103], v131 offset:1944
    s_waitcnt lgkmcnt(6)
    v_mfma_f32_16x16x32_bf16 v[44:47], v[80:83], v[124:127], v[44:47]
    ds_read_b64_tr_b16 v[104:105], v131 offset:160
    ds_read_b64_tr_b16 v[106:107], v131 offset:1952
    v_mfma_f32_16x16x32_bf16 v[48:51], v[84:87], v[124:127], v[48:51]
    ds_read_b64_tr_b16 v[108:109], v132 offset:0
    ds_read_b64_tr_b16 v[110:111], v132 offset:1792
    v_mfma_f32_16x16x32_bf16 v[52:55], v[88:91], v[124:127], v[52:55]
    ds_read_b64_tr_b16 v[80:81], v131 offset:168
    ds_read_b64_tr_b16 v[82:83], v131 offset:1960
    s_waitcnt lgkmcnt(6)
    v_mfma_f32_16x16x32_bf16 v[72:75], v[120:123], v[92:95], v[72:75]
    v_mfma_f32_16x16x32_bf16 v[76:79], v[124:127], v[92:95], v[76:79]
    ds_read_b64_tr_b16 v[84:85], v131 offset:176
    ds_read_b64_tr_b16 v[86:87], v131 offset:1968
    v_mfma_f32_16x16x32_bf16 v[16:19], v[96:99], v[116:119], v[16:19]
    ds_read_b64_tr_b16 v[88:89], v131 offset:0
    ds_read_b64_tr_b16 v[90:91], v131 offset:1792
    v_mfma_f32_16x16x32_bf16 v[20:23], v[100:103], v[116:119], v[20:23]
    ds_read_b64_tr_b16 v[92:93], v131 offset:8
    ds_read_b64_tr_b16 v[94:95], v131 offset:1800
    s_waitcnt lgkmcnt(6)
    v_mfma_f32_16x16x32_bf16 v[24:27], v[104:107], v[116:119], v[24:27]
    ds_read_b64_tr_b16 v[96:97], v132 offset:64
    ds_read_b64_tr_b16 v[98:99], v132 offset:1856
    v_mfma_f32_16x16x32_bf16 v[56:59], v[112:115], v[108:111], v[56:59]
    v_mfma_f32_16x16x32_bf16 v[60:63], v[116:119], v[108:111], v[60:63]
    ds_read_b64_tr_b16 v[100:101], v131 offset:16
    ds_read_b64_tr_b16 v[102:103], v131 offset:1808
    s_barrier
    ds_read_b128 v[120:123], v135 offset:32768
    ds_read_b128 v[124:127], v135 offset:34816
    v_mfma_f32_16x16x32_bf16 v[28:31], v[80:83], v[116:119], v[28:31]
    ds_read_b64_tr_b16 v[104:105], v131 offset:24
    ds_read_b64_tr_b16 v[106:107], v131 offset:1816
    s_waitcnt lgkmcnt(8)
    v_mfma_f32_16x16x32_bf16 v[32:35], v[84:87], v[116:119], v[32:35]
    ds_read_b64_tr_b16 v[108:109], v131 offset:32
    ds_read_b64_tr_b16 v[110:111], v131 offset:1824
    v_mfma_f32_16x16x32_bf16 v[36:39], v[88:91], v[116:119], v[36:39]
    ds_read_b64_tr_b16 v[80:81], v133 offset:64
    ds_read_b64_tr_b16 v[82:83], v133 offset:1856
    v_mfma_f32_16x16x32_bf16 v[40:43], v[92:95], v[116:119], v[40:43]
    ds_read_b64_tr_b16 v[84:85], v131 offset:14480
    ds_read_b64_tr_b16 v[86:87], v131 offset:16272
    s_waitcnt lgkmcnt(6)
    v_mfma_f32_16x16x32_bf16 v[64:67], v[112:115], v[96:99], v[64:67]
    v_mfma_f32_16x16x32_bf16 v[68:71], v[116:119], v[96:99], v[68:71]
    ds_read_b64_tr_b16 v[88:89], v131 offset:14488
    ds_read_b64_tr_b16 v[90:91], v131 offset:16280
    v_mfma_f32_16x16x32_bf16 v[44:47], v[100:103], v[116:119], v[44:47]
    ds_read_b64_tr_b16 v[92:93], v131 offset:14496
    ds_read_b64_tr_b16 v[94:95], v131 offset:16288
    v_mfma_f32_16x16x32_bf16 v[48:51], v[104:107], v[116:119], v[48:51]
    ds_read_b64_tr_b16 v[96:97], v132 offset:14336
    ds_read_b64_tr_b16 v[98:99], v132 offset:16128
    s_waitcnt lgkmcnt(6)
    v_mfma_f32_16x16x32_bf16 v[52:55], v[108:111], v[116:119], v[52:55]
    ds_read_b64_tr_b16 v[100:101], v131 offset:14504
    ds_read_b64_tr_b16 v[102:103], v131 offset:16296
    v_mfma_f32_16x16x32_bf16 v[72:75], v[112:115], v[80:83], v[72:75]
    v_mfma_f32_16x16x32_bf16 v[76:79], v[116:119], v[80:83], v[76:79]
    ds_read_b64_tr_b16 v[104:105], v131 offset:14512
    ds_read_b64_tr_b16 v[106:107], v131 offset:16304
    v_mfma_f32_16x16x32_bf16 v[16:19], v[84:87], v[124:127], v[16:19]
    ds_read_b64_tr_b16 v[108:109], v131 offset:14336
    ds_read_b64_tr_b16 v[110:111], v131 offset:16128
    s_waitcnt lgkmcnt(6)
    v_mfma_f32_16x16x32_bf16 v[20:23], v[88:91], v[124:127], v[20:23]
    ds_read_b64_tr_b16 v[80:81], v131 offset:14344
    ds_read_b64_tr_b16 v[82:83], v131 offset:16136
    v_mfma_f32_16x16x32_bf16 v[24:27], v[92:95], v[124:127], v[24:27]
    ds_read_b64_tr_b16 v[84:85], v132 offset:14400
    ds_read_b64_tr_b16 v[86:87], v132 offset:16192
    v_mfma_f32_16x16x32_bf16 v[56:59], v[120:123], v[96:99], v[56:59]
    v_mfma_f32_16x16x32_bf16 v[60:63], v[124:127], v[96:99], v[60:63]
    ds_read_b64_tr_b16 v[88:89], v131 offset:14352
    ds_read_b64_tr_b16 v[90:91], v131 offset:16144
    s_barrier
    ds_read_b128 v[112:115], v134 offset:0
    ds_read_b128 v[116:119], v134 offset:2048
    s_waitcnt lgkmcnt(8)
    v_mfma_f32_16x16x32_bf16 v[28:31], v[100:103], v[124:127], v[28:31]
    ds_read_b64_tr_b16 v[92:93], v131 offset:14360
    ds_read_b64_tr_b16 v[94:95], v131 offset:16152
    v_mfma_f32_16x16x32_bf16 v[32:35], v[104:107], v[124:127], v[32:35]
    ds_read_b64_tr_b16 v[96:97], v131 offset:14368
    ds_read_b64_tr_b16 v[98:99], v131 offset:16160
    v_mfma_f32_16x16x32_bf16 v[36:39], v[108:111], v[124:127], v[36:39]
    ds_read_b64_tr_b16 v[100:101], v133 offset:14400
    ds_read_b64_tr_b16 v[102:103], v133 offset:16192
    s_waitcnt lgkmcnt(8)
    v_mfma_f32_16x16x32_bf16 v[40:43], v[80:83], v[124:127], v[40:43]
    ds_read_b64_tr_b16 v[104:105], v131 offset:28816
    ds_read_b64_tr_b16 v[106:107], v131 offset:30608
    v_mfma_f32_16x16x32_bf16 v[64:67], v[120:123], v[84:87], v[64:67]
    v_mfma_f32_16x16x32_bf16 v[68:71], v[124:127], v[84:87], v[68:71]
    ds_read_b64_tr_b16 v[108:109], v131 offset:28824
    ds_read_b64_tr_b16 v[110:111], v131 offset:30616
    v_mfma_f32_16x16x32_bf16 v[44:47], v[88:91], v[124:127], v[44:47]
    ds_read_b64_tr_b16 v[80:81], v131 offset:28832
    ds_read_b64_tr_b16 v[82:83], v131 offset:30624
    s_waitcnt lgkmcnt(6)
    v_mfma_f32_16x16x32_bf16 v[48:51], v[92:95], v[124:127], v[48:51]
    ds_read_b64_tr_b16 v[84:85], v132 offset:28672
    ds_read_b64_tr_b16 v[86:87], v132 offset:30464
    v_mfma_f32_16x16x32_bf16 v[52:55], v[96:99], v[124:127], v[52:55]
    ds_read_b64_tr_b16 v[88:89], v131 offset:28840
    ds_read_b64_tr_b16 v[90:91], v131 offset:30632
    v_mfma_f32_16x16x32_bf16 v[72:75], v[120:123], v[100:103], v[72:75]
    v_mfma_f32_16x16x32_bf16 v[76:79], v[124:127], v[100:103], v[76:79]
    ds_read_b64_tr_b16 v[92:93], v131 offset:28848
    ds_read_b64_tr_b16 v[94:95], v131 offset:30640
    s_waitcnt lgkmcnt(6)
    v_mfma_f32_16x16x32_bf16 v[16:19], v[104:107], v[116:119], v[16:19]
    ds_read_b64_tr_b16 v[96:97], v131 offset:28672
    ds_read_b64_tr_b16 v[98:99], v131 offset:30464
    v_mfma_f32_16x16x32_bf16 v[20:23], v[108:111], v[116:119], v[20:23]
    ds_read_b64_tr_b16 v[100:101], v131 offset:28680
    ds_read_b64_tr_b16 v[102:103], v131 offset:30472
    v_mfma_f32_16x16x32_bf16 v[24:27], v[80:83], v[116:119], v[24:27]
    ds_read_b64_tr_b16 v[104:105], v132 offset:28736
    ds_read_b64_tr_b16 v[106:107], v132 offset:30528
    s_waitcnt lgkmcnt(6)
    v_mfma_f32_16x16x32_bf16 v[56:59], v[112:115], v[84:87], v[56:59]
    v_mfma_f32_16x16x32_bf16 v[60:63], v[116:119], v[84:87], v[60:63]
    ds_read_b64_tr_b16 v[108:109], v131 offset:28688
    ds_read_b64_tr_b16 v[110:111], v131 offset:30480
    s_barrier
    ds_read_b128 v[120:123], v135 offset:0
    ds_read_b128 v[124:127], v135 offset:2048
    v_mfma_f32_16x16x32_bf16 v[28:31], v[88:91], v[116:119], v[28:31]
    ds_read_b64_tr_b16 v[80:81], v131 offset:28696
    ds_read_b64_tr_b16 v[82:83], v131 offset:30488
    v_mfma_f32_16x16x32_bf16 v[32:35], v[92:95], v[116:119], v[32:35]
    ds_read_b64_tr_b16 v[84:85], v131 offset:28704
    ds_read_b64_tr_b16 v[86:87], v131 offset:30496
    s_waitcnt lgkmcnt(8)
    v_mfma_f32_16x16x32_bf16 v[36:39], v[96:99], v[116:119], v[36:39]
    ds_read_b64_tr_b16 v[88:89], v133 offset:28736
    ds_read_b64_tr_b16 v[90:91], v133 offset:30528
    v_mfma_f32_16x16x32_bf16 v[40:43], v[100:103], v[116:119], v[40:43]
    ds_read_b64_tr_b16 v[92:93], v128 offset:144
    ds_read_b64_tr_b16 v[94:95], v128 offset:1936
    v_mfma_f32_16x16x32_bf16 v[64:67], v[112:115], v[104:107], v[64:67]
    v_mfma_f32_16x16x32_bf16 v[68:71], v[116:119], v[104:107], v[68:71]
    ds_read_b64_tr_b16 v[96:97], v128 offset:152
    ds_read_b64_tr_b16 v[98:99], v128 offset:1944
    s_waitcnt lgkmcnt(6)
    v_mfma_f32_16x16x32_bf16 v[44:47], v[108:111], v[116:119], v[44:47]
    ds_read_b64_tr_b16 v[100:101], v128 offset:160
    ds_read_b64_tr_b16 v[102:103], v128 offset:1952
    v_mfma_f32_16x16x32_bf16 v[48:51], v[80:83], v[116:119], v[48:51]
    ds_read_b64_tr_b16 v[104:105], v129 offset:0
    ds_read_b64_tr_b16 v[106:107], v129 offset:1792
    v_mfma_f32_16x16x32_bf16 v[52:55], v[84:87], v[116:119], v[52:55]
    ds_read_b64_tr_b16 v[108:109], v128 offset:168
    ds_read_b64_tr_b16 v[110:111], v128 offset:1960
    s_waitcnt lgkmcnt(6)
    v_mfma_f32_16x16x32_bf16 v[72:75], v[112:115], v[88:91], v[72:75]
    v_mfma_f32_16x16x32_bf16 v[76:79], v[116:119], v[88:91], v[76:79]
    ds_read_b64_tr_b16 v[80:81], v128 offset:176
    ds_read_b64_tr_b16 v[82:83], v128 offset:1968
    v_mfma_f32_16x16x32_bf16 v[16:19], v[92:95], v[124:127], v[16:19]
    ds_read_b64_tr_b16 v[84:85], v128 offset:0
    ds_read_b64_tr_b16 v[86:87], v128 offset:1792
    v_mfma_f32_16x16x32_bf16 v[20:23], v[96:99], v[124:127], v[20:23]
    ds_read_b64_tr_b16 v[88:89], v128 offset:8
    ds_read_b64_tr_b16 v[90:91], v128 offset:1800
    s_waitcnt lgkmcnt(6)
    v_mfma_f32_16x16x32_bf16 v[24:27], v[100:103], v[124:127], v[24:27]
    ds_read_b64_tr_b16 v[92:93], v129 offset:64
    ds_read_b64_tr_b16 v[94:95], v129 offset:1856
    v_mfma_f32_16x16x32_bf16 v[56:59], v[120:123], v[104:107], v[56:59]
    v_mfma_f32_16x16x32_bf16 v[60:63], v[124:127], v[104:107], v[60:63]
    ds_read_b64_tr_b16 v[96:97], v128 offset:16
    ds_read_b64_tr_b16 v[98:99], v128 offset:1808
    s_barrier
    ds_read_b128 v[112:115], v134 offset:16384
    ds_read_b128 v[116:119], v134 offset:18432
    v_mfma_f32_16x16x32_bf16 v[28:31], v[108:111], v[124:127], v[28:31]
    ds_read_b64_tr_b16 v[100:101], v128 offset:24
    ds_read_b64_tr_b16 v[102:103], v128 offset:1816
    s_waitcnt lgkmcnt(8)
    v_mfma_f32_16x16x32_bf16 v[32:35], v[80:83], v[124:127], v[32:35]
    ds_read_b64_tr_b16 v[104:105], v128 offset:32
    ds_read_b64_tr_b16 v[106:107], v128 offset:1824
    v_mfma_f32_16x16x32_bf16 v[36:39], v[84:87], v[124:127], v[36:39]
    ds_read_b64_tr_b16 v[108:109], v130 offset:64
    ds_read_b64_tr_b16 v[110:111], v130 offset:1856
    v_mfma_f32_16x16x32_bf16 v[40:43], v[88:91], v[124:127], v[40:43]
    ds_read_b64_tr_b16 v[80:81], v128 offset:14480
    ds_read_b64_tr_b16 v[82:83], v128 offset:16272
    s_waitcnt lgkmcnt(6)
    v_mfma_f32_16x16x32_bf16 v[64:67], v[120:123], v[92:95], v[64:67]
    v_mfma_f32_16x16x32_bf16 v[68:71], v[124:127], v[92:95], v[68:71]
    ds_read_b64_tr_b16 v[84:85], v128 offset:14488
    ds_read_b64_tr_b16 v[86:87], v128 offset:16280
    v_mfma_f32_16x16x32_bf16 v[44:47], v[96:99], v[124:127], v[44:47]
    ds_read_b64_tr_b16 v[88:89], v128 offset:14496
    ds_read_b64_tr_b16 v[90:91], v128 offset:16288
    v_mfma_f32_16x16x32_bf16 v[48:51], v[100:103], v[124:127], v[48:51]
    ds_read_b64_tr_b16 v[92:93], v129 offset:14336
    ds_read_b64_tr_b16 v[94:95], v129 offset:16128
    s_waitcnt lgkmcnt(6)
    v_mfma_f32_16x16x32_bf16 v[52:55], v[104:107], v[124:127], v[52:55]
    ds_read_b64_tr_b16 v[96:97], v128 offset:14504
    ds_read_b64_tr_b16 v[98:99], v128 offset:16296
    v_mfma_f32_16x16x32_bf16 v[72:75], v[120:123], v[108:111], v[72:75]
    v_mfma_f32_16x16x32_bf16 v[76:79], v[124:127], v[108:111], v[76:79]
    ds_read_b64_tr_b16 v[100:101], v128 offset:14512
    ds_read_b64_tr_b16 v[102:103], v128 offset:16304
    v_mfma_f32_16x16x32_bf16 v[16:19], v[80:83], v[116:119], v[16:19]
    ds_read_b64_tr_b16 v[104:105], v128 offset:14336
    ds_read_b64_tr_b16 v[106:107], v128 offset:16128
    s_waitcnt lgkmcnt(6)
    v_mfma_f32_16x16x32_bf16 v[20:23], v[84:87], v[116:119], v[20:23]
    ds_read_b64_tr_b16 v[108:109], v128 offset:14344
    ds_read_b64_tr_b16 v[110:111], v128 offset:16136
    v_mfma_f32_16x16x32_bf16 v[24:27], v[88:91], v[116:119], v[24:27]
    ds_read_b64_tr_b16 v[80:81], v129 offset:14400
    ds_read_b64_tr_b16 v[82:83], v129 offset:16192
    v_mfma_f32_16x16x32_bf16 v[56:59], v[112:115], v[92:95], v[56:59]
    v_mfma_f32_16x16x32_bf16 v[60:63], v[116:119], v[92:95], v[60:63]
    ds_read_b64_tr_b16 v[84:85], v128 offset:14352
    ds_read_b64_tr_b16 v[86:87], v128 offset:16144
    s_barrier
    ds_read_b128 v[120:123], v135 offset:16384
    ds_read_b128 v[124:127], v135 offset:18432
    s_waitcnt lgkmcnt(8)
    v_mfma_f32_16x16x32_bf16 v[28:31], v[96:99], v[116:119], v[28:31]
    ds_read_b64_tr_b16 v[88:89], v128 offset:14360
    ds_read_b64_tr_b16 v[90:91], v128 offset:16152
    v_mfma_f32_16x16x32_bf16 v[32:35], v[100:103], v[116:119], v[32:35]
    ds_read_b64_tr_b16 v[92:93], v128 offset:14368
    ds_read_b64_tr_b16 v[94:95], v128 offset:16160
    v_mfma_f32_16x16x32_bf16 v[36:39], v[104:107], v[116:119], v[36:39]
    ds_read_b64_tr_b16 v[96:97], v130 offset:14400
    ds_read_b64_tr_b16 v[98:99], v130 offset:16192
    s_waitcnt lgkmcnt(8)
    v_mfma_f32_16x16x32_bf16 v[40:43], v[108:111], v[116:119], v[40:43]
    ds_read_b64_tr_b16 v[100:101], v128 offset:28816
    ds_read_b64_tr_b16 v[102:103], v128 offset:30608
    v_mfma_f32_16x16x32_bf16 v[64:67], v[112:115], v[80:83], v[64:67]
    v_mfma_f32_16x16x32_bf16 v[68:71], v[116:119], v[80:83], v[68:71]
    ds_read_b64_tr_b16 v[104:105], v128 offset:28824
    ds_read_b64_tr_b16 v[106:107], v128 offset:30616
    v_mfma_f32_16x16x32_bf16 v[44:47], v[84:87], v[116:119], v[44:47]
    ds_read_b64_tr_b16 v[108:109], v128 offset:28832
    ds_read_b64_tr_b16 v[110:111], v128 offset:30624
    s_waitcnt lgkmcnt(6)
    v_mfma_f32_16x16x32_bf16 v[48:51], v[88:91], v[116:119], v[48:51]
    ds_read_b64_tr_b16 v[80:81], v129 offset:28672
    ds_read_b64_tr_b16 v[82:83], v129 offset:30464
    v_mfma_f32_16x16x32_bf16 v[52:55], v[92:95], v[116:119], v[52:55]
    ds_read_b64_tr_b16 v[84:85], v128 offset:28840
    ds_read_b64_tr_b16 v[86:87], v128 offset:30632
    v_mfma_f32_16x16x32_bf16 v[72:75], v[112:115], v[96:99], v[72:75]
    v_mfma_f32_16x16x32_bf16 v[76:79], v[116:119], v[96:99], v[76:79]
    ds_read_b64_tr_b16 v[88:89], v128 offset:28848
    ds_read_b64_tr_b16 v[90:91], v128 offset:30640
    s_waitcnt lgkmcnt(6)
    v_mfma_f32_16x16x32_bf16 v[16:19], v[100:103], v[124:127], v[16:19]
    ds_read_b64_tr_b16 v[92:93], v128 offset:28672
    ds_read_b64_tr_b16 v[94:95], v128 offset:30464
    v_mfma_f32_16x16x32_bf16 v[20:23], v[104:107], v[124:127], v[20:23]
    ds_read_b64_tr_b16 v[96:97], v128 offset:28680
    ds_read_b64_tr_b16 v[98:99], v128 offset:30472
    v_mfma_f32_16x16x32_bf16 v[24:27], v[108:111], v[124:127], v[24:27]
    ds_read_b64_tr_b16 v[100:101], v129 offset:28736
    ds_read_b64_tr_b16 v[102:103], v129 offset:30528
    s_waitcnt lgkmcnt(6)
    v_mfma_f32_16x16x32_bf16 v[56:59], v[120:123], v[80:83], v[56:59]
    v_mfma_f32_16x16x32_bf16 v[60:63], v[124:127], v[80:83], v[60:63]
    ds_read_b64_tr_b16 v[104:105], v128 offset:28688
    ds_read_b64_tr_b16 v[106:107], v128 offset:30480
    s_barrier
    ds_read_b128 v[112:115], v134 offset:32768
    ds_read_b128 v[116:119], v134 offset:34816
    v_mfma_f32_16x16x32_bf16 v[28:31], v[84:87], v[124:127], v[28:31]
    ds_read_b64_tr_b16 v[108:109], v128 offset:28696
    ds_read_b64_tr_b16 v[110:111], v128 offset:30488
    v_mfma_f32_16x16x32_bf16 v[32:35], v[88:91], v[124:127], v[32:35]
    ds_read_b64_tr_b16 v[80:81], v128 offset:28704
    ds_read_b64_tr_b16 v[82:83], v128 offset:30496
    s_waitcnt lgkmcnt(8)
    v_mfma_f32_16x16x32_bf16 v[36:39], v[92:95], v[124:127], v[36:39]
    ds_read_b64_tr_b16 v[84:85], v130 offset:28736
    ds_read_b64_tr_b16 v[86:87], v130 offset:30528
    v_mfma_f32_16x16x32_bf16 v[40:43], v[96:99], v[124:127], v[40:43]
    ds_read_b64_tr_b16 v[88:89], v128 offset:43152
    ds_read_b64_tr_b16 v[90:91], v128 offset:44944
    v_mfma_f32_16x16x32_bf16 v[64:67], v[120:123], v[100:103], v[64:67]
    v_mfma_f32_16x16x32_bf16 v[68:71], v[124:127], v[100:103], v[68:71]
    ds_read_b64_tr_b16 v[92:93], v128 offset:43160
    ds_read_b64_tr_b16 v[94:95], v128 offset:44952
    s_waitcnt lgkmcnt(6)
    v_mfma_f32_16x16x32_bf16 v[44:47], v[104:107], v[124:127], v[44:47]
    ds_read_b64_tr_b16 v[96:97], v128 offset:43168
    ds_read_b64_tr_b16 v[98:99], v128 offset:44960
    v_mfma_f32_16x16x32_bf16 v[48:51], v[108:111], v[124:127], v[48:51]
    ds_read_b64_tr_b16 v[100:101], v129 offset:43008
    ds_read_b64_tr_b16 v[102:103], v129 offset:44800
    v_mfma_f32_16x16x32_bf16 v[52:55], v[80:83], v[124:127], v[52:55]
    ds_read_b64_tr_b16 v[104:105], v128 offset:43176
    ds_read_b64_tr_b16 v[106:107], v128 offset:44968
    s_waitcnt lgkmcnt(6)
    v_mfma_f32_16x16x32_bf16 v[72:75], v[120:123], v[84:87], v[72:75]
    v_mfma_f32_16x16x32_bf16 v[76:79], v[124:127], v[84:87], v[76:79]
    ds_read_b64_tr_b16 v[108:109], v128 offset:43184
    ds_read_b64_tr_b16 v[110:111], v128 offset:44976
    v_mfma_f32_16x16x32_bf16 v[16:19], v[88:91], v[116:119], v[16:19]
    ds_read_b64_tr_b16 v[80:81], v128 offset:43008
    ds_read_b64_tr_b16 v[82:83], v128 offset:44800
    v_mfma_f32_16x16x32_bf16 v[20:23], v[92:95], v[116:119], v[20:23]
    ds_read_b64_tr_b16 v[84:85], v128 offset:43016
    ds_read_b64_tr_b16 v[86:87], v128 offset:44808
    s_waitcnt lgkmcnt(6)
    v_mfma_f32_16x16x32_bf16 v[24:27], v[96:99], v[116:119], v[24:27]
    ds_read_b64_tr_b16 v[88:89], v129 offset:43072
    ds_read_b64_tr_b16 v[90:91], v129 offset:44864
    v_mfma_f32_16x16x32_bf16 v[56:59], v[112:115], v[100:103], v[56:59]
    v_mfma_f32_16x16x32_bf16 v[60:63], v[116:119], v[100:103], v[60:63]
    ds_read_b64_tr_b16 v[92:93], v128 offset:43024
    ds_read_b64_tr_b16 v[94:95], v128 offset:44816
    s_barrier
    ds_read_b128 v[120:123], v135 offset:32768
    ds_read_b128 v[124:127], v135 offset:34816
    v_mfma_f32_16x16x32_bf16 v[28:31], v[104:107], v[116:119], v[28:31]
    ds_read_b64_tr_b16 v[96:97], v128 offset:43032
    ds_read_b64_tr_b16 v[98:99], v128 offset:44824
    s_waitcnt lgkmcnt(8)
    v_mfma_f32_16x16x32_bf16 v[32:35], v[108:111], v[116:119], v[32:35]
    ds_read_b64_tr_b16 v[100:101], v128 offset:43040
    ds_read_b64_tr_b16 v[102:103], v128 offset:44832
    v_mfma_f32_16x16x32_bf16 v[36:39], v[80:83], v[116:119], v[36:39]
    ds_read_b64_tr_b16 v[104:105], v130 offset:43072
    ds_read_b64_tr_b16 v[106:107], v130 offset:44864
    v_mfma_f32_16x16x32_bf16 v[40:43], v[84:87], v[116:119], v[40:43]
    ds_read_b64_tr_b16 v[108:109], v131 offset:144
    ds_read_b64_tr_b16 v[110:111], v131 offset:1936
    s_waitcnt lgkmcnt(6)
    v_mfma_f32_16x16x32_bf16 v[64:67], v[112:115], v[88:91], v[64:67]
    v_mfma_f32_16x16x32_bf16 v[68:71], v[116:119], v[88:91], v[68:71]
    ds_read_b64_tr_b16 v[80:81], v131 offset:152
    ds_read_b64_tr_b16 v[82:83], v131 offset:1944
    v_mfma_f32_16x16x32_bf16 v[44:47], v[92:95], v[116:119], v[44:47]
    ds_read_b64_tr_b16 v[84:85], v131 offset:160
    ds_read_b64_tr_b16 v[86:87], v131 offset:1952
    v_mfma_f32_16x16x32_bf16 v[48:51], v[96:99], v[116:119], v[48:51]
    ds_read_b64_tr_b16 v[88:89], v132 offset:0
    ds_read_b64_tr_b16 v[90:91], v132 offset:1792
    s_waitcnt lgkmcnt(6)
    v_mfma_f32_16x16x32_bf16 v[52:55], v[100:103], v[116:119], v[52:55]
    ds_read_b64_tr_b16 v[92:93], v131 offset:168
    ds_read_b64_tr_b16 v[94:95], v131 offset:1960
    v_mfma_f32_16x16x32_bf16 v[72:75], v[112:115], v[104:107], v[72:75]
    v_mfma_f32_16x16x32_bf16 v[76:79], v[116:119], v[104:107], v[76:79]
    ds_read_b64_tr_b16 v[96:97], v131 offset:176
    ds_read_b64_tr_b16 v[98:99], v131 offset:1968
    v_mfma_f32_16x16x32_bf16 v[16:19], v[108:111], v[124:127], v[16:19]
    ds_read_b64_tr_b16 v[100:101], v131 offset:0
    ds_read_b64_tr_b16 v[102:103], v131 offset:1792
    s_waitcnt lgkmcnt(6)
    v_mfma_f32_16x16x32_bf16 v[20:23], v[80:83], v[124:127], v[20:23]
    ds_read_b64_tr_b16 v[104:105], v131 offset:8
    ds_read_b64_tr_b16 v[106:107], v131 offset:1800
    v_mfma_f32_16x16x32_bf16 v[24:27], v[84:87], v[124:127], v[24:27]
    ds_read_b64_tr_b16 v[108:109], v132 offset:64
    ds_read_b64_tr_b16 v[110:111], v132 offset:1856
    v_mfma_f32_16x16x32_bf16 v[56:59], v[120:123], v[88:91], v[56:59]
    v_mfma_f32_16x16x32_bf16 v[60:63], v[124:127], v[88:91], v[60:63]
    ds_read_b64_tr_b16 v[80:81], v131 offset:16
    ds_read_b64_tr_b16 v[82:83], v131 offset:1808
    s_barrier
    ds_read_b128 v[112:115], v134 offset:0
    ds_read_b128 v[116:119], v134 offset:2048
    s_waitcnt lgkmcnt(8)
    v_mfma_f32_16x16x32_bf16 v[28:31], v[92:95], v[124:127], v[28:31]
    ds_read_b64_tr_b16 v[84:85], v131 offset:24
    ds_read_b64_tr_b16 v[86:87], v131 offset:1816
    v_mfma_f32_16x16x32_bf16 v[32:35], v[96:99], v[124:127], v[32:35]
    ds_read_b64_tr_b16 v[88:89], v131 offset:32
    ds_read_b64_tr_b16 v[90:91], v131 offset:1824
    v_mfma_f32_16x16x32_bf16 v[36:39], v[100:103], v[124:127], v[36:39]
    ds_read_b64_tr_b16 v[92:93], v133 offset:64
    ds_read_b64_tr_b16 v[94:95], v133 offset:1856
    s_waitcnt lgkmcnt(8)
    v_mfma_f32_16x16x32_bf16 v[40:43], v[104:107], v[124:127], v[40:43]
    ds_read_b64_tr_b16 v[96:97], v131 offset:14480
    ds_read_b64_tr_b16 v[98:99], v131 offset:16272
    v_mfma_f32_16x16x32_bf16 v[64:67], v[120:123], v[108:111], v[64:67]
    v_mfma_f32_16x16x32_bf16 v[68:71], v[124:127], v[108:111], v[68:71]
    ds_read_b64_tr_b16 v[100:101], v131 offset:14488
    ds_read_b64_tr_b16 v[102:103], v131 offset:16280
    v_mfma_f32_16x16x32_bf16 v[44:47], v[80:83], v[124:127], v[44:47]
    ds_read_b64_tr_b16 v[104:105], v131 offset:14496
    ds_read_b64_tr_b16 v[106:107], v131 offset:16288
    s_waitcnt lgkmcnt(6)
    v_mfma_f32_16x16x32_bf16 v[48:51], v[84:87], v[124:127], v[48:51]
    ds_read_b64_tr_b16 v[108:109], v132 offset:14336
    ds_read_b64_tr_b16 v[110:111], v132 offset:16128
    v_mfma_f32_16x16x32_bf16 v[52:55], v[88:91], v[124:127], v[52:55]
    ds_read_b64_tr_b16 v[80:81], v131 offset:14504
    ds_read_b64_tr_b16 v[82:83], v131 offset:16296
    v_mfma_f32_16x16x32_bf16 v[72:75], v[120:123], v[92:95], v[72:75]
    v_mfma_f32_16x16x32_bf16 v[76:79], v[124:127], v[92:95], v[76:79]
    ds_read_b64_tr_b16 v[84:85], v131 offset:14512
    ds_read_b64_tr_b16 v[86:87], v131 offset:16304
    s_waitcnt lgkmcnt(6)
    v_mfma_f32_16x16x32_bf16 v[16:19], v[96:99], v[116:119], v[16:19]
    ds_read_b64_tr_b16 v[88:89], v131 offset:14336
    ds_read_b64_tr_b16 v[90:91], v131 offset:16128
    v_mfma_f32_16x16x32_bf16 v[20:23], v[100:103], v[116:119], v[20:23]
    ds_read_b64_tr_b16 v[92:93], v131 offset:14344
    ds_read_b64_tr_b16 v[94:95], v131 offset:16136
    v_mfma_f32_16x16x32_bf16 v[24:27], v[104:107], v[116:119], v[24:27]
    ds_read_b64_tr_b16 v[96:97], v132 offset:14400
    ds_read_b64_tr_b16 v[98:99], v132 offset:16192
    s_waitcnt lgkmcnt(6)
    v_mfma_f32_16x16x32_bf16 v[56:59], v[112:115], v[108:111], v[56:59]
    v_mfma_f32_16x16x32_bf16 v[60:63], v[116:119], v[108:111], v[60:63]
    ds_read_b64_tr_b16 v[100:101], v131 offset:14352
    ds_read_b64_tr_b16 v[102:103], v131 offset:16144
    s_barrier
    ds_read_b128 v[120:123], v135 offset:0
    ds_read_b128 v[124:127], v135 offset:2048
    v_mfma_f32_16x16x32_bf16 v[28:31], v[80:83], v[116:119], v[28:31]
    ds_read_b64_tr_b16 v[104:105], v131 offset:14360
    ds_read_b64_tr_b16 v[106:107], v131 offset:16152
    v_mfma_f32_16x16x32_bf16 v[32:35], v[84:87], v[116:119], v[32:35]
    ds_read_b64_tr_b16 v[108:109], v131 offset:14368
    ds_read_b64_tr_b16 v[110:111], v131 offset:16160
    s_waitcnt lgkmcnt(8)
    v_mfma_f32_16x16x32_bf16 v[36:39], v[88:91], v[116:119], v[36:39]
    ds_read_b64_tr_b16 v[80:81], v133 offset:14400
    ds_read_b64_tr_b16 v[82:83], v133 offset:16192
    v_mfma_f32_16x16x32_bf16 v[40:43], v[92:95], v[116:119], v[40:43]
    ds_read_b64_tr_b16 v[84:85], v131 offset:28816
    ds_read_b64_tr_b16 v[86:87], v131 offset:30608
    v_mfma_f32_16x16x32_bf16 v[64:67], v[112:115], v[96:99], v[64:67]
    v_mfma_f32_16x16x32_bf16 v[68:71], v[116:119], v[96:99], v[68:71]
    ds_read_b64_tr_b16 v[88:89], v131 offset:28824
    ds_read_b64_tr_b16 v[90:91], v131 offset:30616
    s_waitcnt lgkmcnt(6)
    v_mfma_f32_16x16x32_bf16 v[44:47], v[100:103], v[116:119], v[44:47]
    ds_read_b64_tr_b16 v[92:93], v131 offset:28832
    ds_read_b64_tr_b16 v[94:95], v131 offset:30624
    v_mfma_f32_16x16x32_bf16 v[48:51], v[104:107], v[116:119], v[48:51]
    ds_read_b64_tr_b16 v[96:97], v132 offset:28672
    ds_read_b64_tr_b16 v[98:99], v132 offset:30464
    v_mfma_f32_16x16x32_bf16 v[52:55], v[108:111], v[116:119], v[52:55]
    ds_read_b64_tr_b16 v[100:101], v131 offset:28840
    ds_read_b64_tr_b16 v[102:103], v131 offset:30632
    s_waitcnt lgkmcnt(6)
    v_mfma_f32_16x16x32_bf16 v[72:75], v[112:115], v[80:83], v[72:75]
    v_mfma_f32_16x16x32_bf16 v[76:79], v[116:119], v[80:83], v[76:79]
    ds_read_b64_tr_b16 v[104:105], v131 offset:28848
    ds_read_b64_tr_b16 v[106:107], v131 offset:30640
    v_mfma_f32_16x16x32_bf16 v[16:19], v[84:87], v[124:127], v[16:19]
    ds_read_b64_tr_b16 v[108:109], v131 offset:28672
    ds_read_b64_tr_b16 v[110:111], v131 offset:30464
    v_mfma_f32_16x16x32_bf16 v[20:23], v[88:91], v[124:127], v[20:23]
    ds_read_b64_tr_b16 v[80:81], v131 offset:28680
    ds_read_b64_tr_b16 v[82:83], v131 offset:30472
    s_waitcnt lgkmcnt(6)
    v_mfma_f32_16x16x32_bf16 v[24:27], v[92:95], v[124:127], v[24:27]
    ds_read_b64_tr_b16 v[84:85], v132 offset:28736
    ds_read_b64_tr_b16 v[86:87], v132 offset:30528
    v_mfma_f32_16x16x32_bf16 v[56:59], v[120:123], v[96:99], v[56:59]
    v_mfma_f32_16x16x32_bf16 v[60:63], v[124:127], v[96:99], v[60:63]
    ds_read_b64_tr_b16 v[88:89], v131 offset:28688
    ds_read_b64_tr_b16 v[90:91], v131 offset:30480
    s_barrier
    ds_read_b128 v[112:115], v134 offset:16384
    ds_read_b128 v[116:119], v134 offset:18432
    v_mfma_f32_16x16x32_bf16 v[28:31], v[100:103], v[124:127], v[28:31]
    ds_read_b64_tr_b16 v[92:93], v131 offset:28696
    ds_read_b64_tr_b16 v[94:95], v131 offset:30488
    s_waitcnt lgkmcnt(8)
    v_mfma_f32_16x16x32_bf16 v[32:35], v[104:107], v[124:127], v[32:35]
    ds_read_b64_tr_b16 v[96:97], v131 offset:28704
    ds_read_b64_tr_b16 v[98:99], v131 offset:30496
    v_mfma_f32_16x16x32_bf16 v[36:39], v[108:111], v[124:127], v[36:39]
    ds_read_b64_tr_b16 v[100:101], v133 offset:28736
    ds_read_b64_tr_b16 v[102:103], v133 offset:30528
    v_mfma_f32_16x16x32_bf16 v[40:43], v[80:83], v[124:127], v[40:43]
    ds_read_b64_tr_b16 v[104:105], v128 offset:144
    ds_read_b64_tr_b16 v[106:107], v128 offset:1936
    s_waitcnt lgkmcnt(6)
    v_mfma_f32_16x16x32_bf16 v[64:67], v[120:123], v[84:87], v[64:67]
    v_mfma_f32_16x16x32_bf16 v[68:71], v[124:127], v[84:87], v[68:71]
    ds_read_b64_tr_b16 v[108:109], v128 offset:152
    ds_read_b64_tr_b16 v[110:111], v128 offset:1944
    v_mfma_f32_16x16x32_bf16 v[44:47], v[88:91], v[124:127], v[44:47]
    ds_read_b64_tr_b16 v[80:81], v128 offset:160
    ds_read_b64_tr_b16 v[82:83], v128 offset:1952
    v_mfma_f32_16x16x32_bf16 v[48:51], v[92:95], v[124:127], v[48:51]
    ds_read_b64_tr_b16 v[84:85], v129 offset:0
    ds_read_b64_tr_b16 v[86:87], v129 offset:1792
    s_waitcnt lgkmcnt(6)
    v_mfma_f32_16x16x32_bf16 v[52:55], v[96:99], v[124:127], v[52:55]
    ds_read_b64_tr_b16 v[88:89], v128 offset:168
    ds_read_b64_tr_b16 v[90:91], v128 offset:1960
    v_mfma_f32_16x16x32_bf16 v[72:75], v[120:123], v[100:103], v[72:75]
    v_mfma_f32_16x16x32_bf16 v[76:79], v[124:127], v[100:103], v[76:79]
    ds_read_b64_tr_b16 v[92:93], v128 offset:176
    ds_read_b64_tr_b16 v[94:95], v128 offset:1968
    v_mfma_f32_16x16x32_bf16 v[16:19], v[104:107], v[116:119], v[16:19]
    ds_read_b64_tr_b16 v[96:97], v128 offset:0
    ds_read_b64_tr_b16 v[98:99], v128 offset:1792
    s_waitcnt lgkmcnt(6)
    v_mfma_f32_16x16x32_bf16 v[20:23], v[108:111], v[116:119], v[20:23]
    ds_read_b64_tr_b16 v[100:101], v128 offset:8
    ds_read_b64_tr_b16 v[102:103], v128 offset:1800
    v_mfma_f32_16x16x32_bf16 v[24:27], v[80:83], v[116:119], v[24:27]
    ds_read_b64_tr_b16 v[104:105], v129 offset:64
    ds_read_b64_tr_b16 v[106:107], v129 offset:1856
    v_mfma_f32_16x16x32_bf16 v[56:59], v[112:115], v[84:87], v[56:59]
    v_mfma_f32_16x16x32_bf16 v[60:63], v[116:119], v[84:87], v[60:63]
    ds_read_b64_tr_b16 v[108:109], v128 offset:16
    ds_read_b64_tr_b16 v[110:111], v128 offset:1808
    s_barrier
    ds_read_b128 v[120:123], v135 offset:16384
    ds_read_b128 v[124:127], v135 offset:18432
    s_waitcnt lgkmcnt(8)
    v_mfma_f32_16x16x32_bf16 v[28:31], v[88:91], v[116:119], v[28:31]
    ds_read_b64_tr_b16 v[80:81], v128 offset:24
    ds_read_b64_tr_b16 v[82:83], v128 offset:1816
    v_mfma_f32_16x16x32_bf16 v[32:35], v[92:95], v[116:119], v[32:35]
    ds_read_b64_tr_b16 v[84:85], v128 offset:32
    ds_read_b64_tr_b16 v[86:87], v128 offset:1824
    v_mfma_f32_16x16x32_bf16 v[36:39], v[96:99], v[116:119], v[36:39]
    ds_read_b64_tr_b16 v[88:89], v130 offset:64
    ds_read_b64_tr_b16 v[90:91], v130 offset:1856
    s_waitcnt lgkmcnt(8)
    v_mfma_f32_16x16x32_bf16 v[40:43], v[100:103], v[116:119], v[40:43]
    ds_read_b64_tr_b16 v[92:93], v128 offset:14480
    ds_read_b64_tr_b16 v[94:95], v128 offset:16272
    v_mfma_f32_16x16x32_bf16 v[64:67], v[112:115], v[104:107], v[64:67]
    v_mfma_f32_16x16x32_bf16 v[68:71], v[116:119], v[104:107], v[68:71]
    ds_read_b64_tr_b16 v[96:97], v128 offset:14488
    ds_read_b64_tr_b16 v[98:99], v128 offset:16280
    v_mfma_f32_16x16x32_bf16 v[44:47], v[108:111], v[116:119], v[44:47]
    ds_read_b64_tr_b16 v[100:101], v128 offset:14496
    ds_read_b64_tr_b16 v[102:103], v128 offset:16288
    s_waitcnt lgkmcnt(6)
    v_mfma_f32_16x16x32_bf16 v[48:51], v[80:83], v[116:119], v[48:51]
    ds_read_b64_tr_b16 v[104:105], v129 offset:14336
    ds_read_b64_tr_b16 v[106:107], v129 offset:16128
    v_mfma_f32_16x16x32_bf16 v[52:55], v[84:87], v[116:119], v[52:55]
    ds_read_b64_tr_b16 v[108:109], v128 offset:14504
    ds_read_b64_tr_b16 v[110:111], v128 offset:16296
    v_mfma_f32_16x16x32_bf16 v[72:75], v[112:115], v[88:91], v[72:75]
    v_mfma_f32_16x16x32_bf16 v[76:79], v[116:119], v[88:91], v[76:79]
    ds_read_b64_tr_b16 v[80:81], v128 offset:14512
    ds_read_b64_tr_b16 v[82:83], v128 offset:16304
    s_waitcnt lgkmcnt(6)
    v_mfma_f32_16x16x32_bf16 v[16:19], v[92:95], v[124:127], v[16:19]
    ds_read_b64_tr_b16 v[84:85], v128 offset:14336
    ds_read_b64_tr_b16 v[86:87], v128 offset:16128
    v_mfma_f32_16x16x32_bf16 v[20:23], v[96:99], v[124:127], v[20:23]
    ds_read_b64_tr_b16 v[88:89], v128 offset:14344
    ds_read_b64_tr_b16 v[90:91], v128 offset:16136
    v_mfma_f32_16x16x32_bf16 v[24:27], v[100:103], v[124:127], v[24:27]
    ds_read_b64_tr_b16 v[92:93], v129 offset:14400
    ds_read_b64_tr_b16 v[94:95], v129 offset:16192
    s_waitcnt lgkmcnt(6)
    v_mfma_f32_16x16x32_bf16 v[56:59], v[120:123], v[104:107], v[56:59]
    v_mfma_f32_16x16x32_bf16 v[60:63], v[124:127], v[104:107], v[60:63]
    ds_read_b64_tr_b16 v[96:97], v128 offset:14352
    ds_read_b64_tr_b16 v[98:99], v128 offset:16144
    s_barrier
    ds_read_b128 v[112:115], v134 offset:32768
    ds_read_b128 v[116:119], v134 offset:34816
    v_mfma_f32_16x16x32_bf16 v[28:31], v[108:111], v[124:127], v[28:31]
    ds_read_b64_tr_b16 v[100:101], v128 offset:14360
    ds_read_b64_tr_b16 v[102:103], v128 offset:16152
    v_mfma_f32_16x16x32_bf16 v[32:35], v[80:83], v[124:127], v[32:35]
    ds_read_b64_tr_b16 v[104:105], v128 offset:14368
    ds_read_b64_tr_b16 v[106:107], v128 offset:16160
    s_waitcnt lgkmcnt(8)
    v_mfma_f32_16x16x32_bf16 v[36:39], v[84:87], v[124:127], v[36:39]
    ds_read_b64_tr_b16 v[108:109], v130 offset:14400
    ds_read_b64_tr_b16 v[110:111], v130 offset:16192
    v_mfma_f32_16x16x32_bf16 v[40:43], v[88:91], v[124:127], v[40:43]
    ds_read_b64_tr_b16 v[80:81], v128 offset:28816
    ds_read_b64_tr_b16 v[82:83], v128 offset:30608
    v_mfma_f32_16x16x32_bf16 v[64:67], v[120:123], v[92:95], v[64:67]
    v_mfma_f32_16x16x32_bf16 v[68:71], v[124:127], v[92:95], v[68:71]
    ds_read_b64_tr_b16 v[84:85], v128 offset:28824
    ds_read_b64_tr_b16 v[86:87], v128 offset:30616
    s_waitcnt lgkmcnt(6)
    v_mfma_f32_16x16x32_bf16 v[44:47], v[96:99], v[124:127], v[44:47]
    ds_read_b64_tr_b16 v[88:89], v128 offset:28832
    ds_read_b64_tr_b16 v[90:91], v128 offset:30624
    v_mfma_f32_16x16x32_bf16 v[48:51], v[100:103], v[124:127], v[48:51]
    ds_read_b64_tr_b16 v[92:93], v129 offset:28672
    ds_read_b64_tr_b16 v[94:95], v129 offset:30464
    v_mfma_f32_16x16x32_bf16 v[52:55], v[104:107], v[124:127], v[52:55]
    ds_read_b64_tr_b16 v[96:97], v128 offset:28840
    ds_read_b64_tr_b16 v[98:99], v128 offset:30632
    s_waitcnt lgkmcnt(6)
    v_mfma_f32_16x16x32_bf16 v[72:75], v[120:123], v[108:111], v[72:75]
    v_mfma_f32_16x16x32_bf16 v[76:79], v[124:127], v[108:111], v[76:79]
    ds_read_b64_tr_b16 v[100:101], v128 offset:28848
    ds_read_b64_tr_b16 v[102:103], v128 offset:30640
    v_mfma_f32_16x16x32_bf16 v[16:19], v[80:83], v[116:119], v[16:19]
    ds_read_b64_tr_b16 v[104:105], v128 offset:28672
    ds_read_b64_tr_b16 v[106:107], v128 offset:30464
    v_mfma_f32_16x16x32_bf16 v[20:23], v[84:87], v[116:119], v[20:23]
    ds_read_b64_tr_b16 v[108:109], v128 offset:28680
    ds_read_b64_tr_b16 v[110:111], v128 offset:30472
    s_waitcnt lgkmcnt(6)
    v_mfma_f32_16x16x32_bf16 v[24:27], v[88:91], v[116:119], v[24:27]
    ds_read_b64_tr_b16 v[80:81], v129 offset:28736
    ds_read_b64_tr_b16 v[82:83], v129 offset:30528
    v_mfma_f32_16x16x32_bf16 v[56:59], v[112:115], v[92:95], v[56:59]
    v_mfma_f32_16x16x32_bf16 v[60:63], v[116:119], v[92:95], v[60:63]
    ds_read_b64_tr_b16 v[84:85], v128 offset:28688
    ds_read_b64_tr_b16 v[86:87], v128 offset:30480
    s_barrier
    ds_read_b128 v[120:123], v135 offset:32768
    ds_read_b128 v[124:127], v135 offset:34816
    v_mfma_f32_16x16x32_bf16 v[28:31], v[96:99], v[116:119], v[28:31]
    ds_read_b64_tr_b16 v[88:89], v128 offset:28696
    ds_read_b64_tr_b16 v[90:91], v128 offset:30488
    s_waitcnt lgkmcnt(8)
    v_mfma_f32_16x16x32_bf16 v[32:35], v[100:103], v[116:119], v[32:35]
    ds_read_b64_tr_b16 v[92:93], v128 offset:28704
    ds_read_b64_tr_b16 v[94:95], v128 offset:30496
    v_mfma_f32_16x16x32_bf16 v[36:39], v[104:107], v[116:119], v[36:39]
    ds_read_b64_tr_b16 v[96:97], v130 offset:28736
    ds_read_b64_tr_b16 v[98:99], v130 offset:30528
    v_mfma_f32_16x16x32_bf16 v[40:43], v[108:111], v[116:119], v[40:43]
    ds_read_b64_tr_b16 v[100:101], v128 offset:43152
    ds_read_b64_tr_b16 v[102:103], v128 offset:44944
    s_waitcnt lgkmcnt(6)
    v_mfma_f32_16x16x32_bf16 v[64:67], v[112:115], v[80:83], v[64:67]
    v_mfma_f32_16x16x32_bf16 v[68:71], v[116:119], v[80:83], v[68:71]
    ds_read_b64_tr_b16 v[104:105], v128 offset:43160
    ds_read_b64_tr_b16 v[106:107], v128 offset:44952
    v_mfma_f32_16x16x32_bf16 v[44:47], v[84:87], v[116:119], v[44:47]
    ds_read_b64_tr_b16 v[108:109], v128 offset:43168
    ds_read_b64_tr_b16 v[110:111], v128 offset:44960
    v_mfma_f32_16x16x32_bf16 v[48:51], v[88:91], v[116:119], v[48:51]
    ds_read_b64_tr_b16 v[80:81], v129 offset:43008
    ds_read_b64_tr_b16 v[82:83], v129 offset:44800
    s_waitcnt lgkmcnt(6)
    v_mfma_f32_16x16x32_bf16 v[52:55], v[92:95], v[116:119], v[52:55]
    ds_read_b64_tr_b16 v[84:85], v128 offset:43176
    ds_read_b64_tr_b16 v[86:87], v128 offset:44968
    v_mfma_f32_16x16x32_bf16 v[72:75], v[112:115], v[96:99], v[72:75]
    v_mfma_f32_16x16x32_bf16 v[76:79], v[116:119], v[96:99], v[76:79]
    ds_read_b64_tr_b16 v[88:89], v128 offset:43184
    ds_read_b64_tr_b16 v[90:91], v128 offset:44976
    v_mfma_f32_16x16x32_bf16 v[16:19], v[100:103], v[124:127], v[16:19]
    ds_read_b64_tr_b16 v[92:93], v128 offset:43008
    ds_read_b64_tr_b16 v[94:95], v128 offset:44800
    s_waitcnt lgkmcnt(6)
    v_mfma_f32_16x16x32_bf16 v[20:23], v[104:107], v[124:127], v[20:23]
    ds_read_b64_tr_b16 v[96:97], v128 offset:43016
    ds_read_b64_tr_b16 v[98:99], v128 offset:44808
    v_mfma_f32_16x16x32_bf16 v[24:27], v[108:111], v[124:127], v[24:27]
    ds_read_b64_tr_b16 v[100:101], v129 offset:43072
    ds_read_b64_tr_b16 v[102:103], v129 offset:44864
    v_mfma_f32_16x16x32_bf16 v[56:59], v[120:123], v[80:83], v[56:59]
    v_mfma_f32_16x16x32_bf16 v[60:63], v[124:127], v[80:83], v[60:63]
    ds_read_b64_tr_b16 v[104:105], v128 offset:43024
    ds_read_b64_tr_b16 v[106:107], v128 offset:44816
    s_waitcnt lgkmcnt(6)
    v_mfma_f32_16x16x32_bf16 v[28:31], v[84:87], v[124:127], v[28:31]
    ds_read_b64_tr_b16 v[108:109], v128 offset:43032
    ds_read_b64_tr_b16 v[110:111], v128 offset:44824
    v_mfma_f32_16x16x32_bf16 v[32:35], v[88:91], v[124:127], v[32:35]
    ds_read_b64_tr_b16 v[80:81], v128 offset:43040
    ds_read_b64_tr_b16 v[82:83], v128 offset:44832
    v_mfma_f32_16x16x32_bf16 v[36:39], v[92:95], v[124:127], v[36:39]
    ds_read_b64_tr_b16 v[84:85], v130 offset:43072
    ds_read_b64_tr_b16 v[86:87], v130 offset:44864
    s_waitcnt lgkmcnt(6)
    v_mfma_f32_16x16x32_bf16 v[40:43], v[96:99], v[124:127], v[40:43]
    v_mfma_f32_16x16x32_bf16 v[64:67], v[120:123], v[100:103], v[64:67]
    v_mfma_f32_16x16x32_bf16 v[68:71], v[124:127], v[100:103], v[68:71]
    v_mfma_f32_16x16x32_bf16 v[44:47], v[104:107], v[124:127], v[44:47]
    s_waitcnt lgkmcnt(0)
    v_mfma_f32_16x16x32_bf16 v[48:51], v[108:111], v[124:127], v[48:51]
    v_mfma_f32_16x16x32_bf16 v[52:55], v[80:83], v[124:127], v[52:55]
    v_mfma_f32_16x16x32_bf16 v[72:75], v[120:123], v[84:87], v[72:75]
    v_mfma_f32_16x16x32_bf16 v[76:79], v[124:127], v[84:87], v[76:79]
    v_mov_b32 v122, 0
    v_mov_b32 v123, 0
    v_cvt_pk_bf16_f32 v112, v36, v37
    v_cvt_pk_bf16_f32 v113, v38, v39
    v_cvt_pk_bf16_f32 v114, v40, v41
    v_cvt_pk_bf16_f32 v115, v42, v43
    v_cvt_pk_bf16_f32 v116, v44, v45
    v_cvt_pk_bf16_f32 v117, v46, v47
    v_cvt_pk_bf16_f32 v118, v48, v49
    v_cvt_pk_bf16_f32 v119, v50, v51
    v_cvt_pk_bf16_f32 v120, v52, v53
    v_cvt_pk_bf16_f32 v121, v54, v55
    s_lshl_b32 s87, s61, 2
    ds_read_b128 v[128:131], v6 offset:0
    ds_read_b128 v[132:135], v6 offset:192
    ds_read_b128 v[136:139], v6 offset:384
    ds_read_b128 v[140:143], v6 offset:576
    ds_read_b128 v[144:147], v6 offset:768
    ds_read_b128 v[148:151], v6 offset:64
    ds_read_b128 v[152:155], v6 offset:256
    ds_read_b128 v[156:159], v6 offset:448
    ds_read_b128 v[160:163], v6 offset:640
    ds_read_b128 v[164:167], v6 offset:832
    s_waitcnt lgkmcnt(5)
    v_mfma_f32_16x16x32_bf16 v[92:95], v[128:131], v[112:115], 0
    v_mfma_f32_16x16x32_bf16 v[96:99], v[132:135], v[112:115], 0
    v_mfma_f32_16x16x32_bf16 v[100:103], v[136:139], v[112:115], 0
    v_mfma_f32_16x16x32_bf16 v[104:107], v[140:143], v[112:115], 0
    v_mfma_f32_16x16x32_bf16 v[108:111], v[144:147], v[112:115], 0
    ds_read_b128 v[128:131], v6 offset:128
    ds_read_b128 v[132:135], v6 offset:320
    ds_read_b128 v[136:139], v6 offset:512
    ds_read_b128 v[140:143], v6 offset:704
    ds_read_b128 v[144:147], v6 offset:896
    s_waitcnt lgkmcnt(5)
    v_mfma_f32_16x16x32_bf16 v[92:95], v[148:151], v[116:119], v[92:95]
    v_mfma_f32_16x16x32_bf16 v[96:99], v[152:155], v[116:119], v[96:99]
    v_mfma_f32_16x16x32_bf16 v[100:103], v[156:159], v[116:119], v[100:103]
    v_mfma_f32_16x16x32_bf16 v[104:107], v[160:163], v[116:119], v[104:107]
    v_mfma_f32_16x16x32_bf16 v[108:111], v[164:167], v[116:119], v[108:111]
    s_waitcnt lgkmcnt(0)
    v_mfma_f32_16x16x32_bf16 v[92:95], v[128:131], v[120:123], v[92:95]
    v_mfma_f32_16x16x32_bf16 v[96:99], v[132:135], v[120:123], v[96:99]
    v_mfma_f32_16x16x32_bf16 v[100:103], v[136:139], v[120:123], v[100:103]
    v_mfma_f32_16x16x32_bf16 v[104:107], v[140:143], v[120:123], v[104:107]
    v_mfma_f32_16x16x32_bf16 v[108:111], v[144:147], v[120:123], v[108:111]
    v_mov_b32 v90, 0
    v_mov_b32 v91, 0
    v_cvt_pk_bf16_f32 v80, v16, v17
    v_cvt_pk_bf16_f32 v81, v18, v19
    v_cvt_pk_bf16_f32 v82, v20, v21
    v_cvt_pk_bf16_f32 v83, v22, v23
    v_cvt_pk_bf16_f32 v84, v24, v25
    v_cvt_pk_bf16_f32 v85, v26, v27
    v_cvt_pk_bf16_f32 v86, v28, v29
    v_cvt_pk_bf16_f32 v87, v30, v31
    v_cvt_pk_bf16_f32 v88, v32, v33
    v_cvt_pk_bf16_f32 v89, v34, v35
    v_lshl_add_u32 v10, v2, 12, v3
    v_lshlrev_b32 v126, 4, v10
    v_lshl_add_u32 v10, v2, 11, v3
    v_lshlrev_b32 v127, 2, v10
    s_lshl_b32 s88, s87, 12
    s_add_u32 s88, s88, s68
    s_lshl_b32 s88, s88, 4
    s_add_u32 s89, s88, 32768
    s_lshl_b32 s90, s87, 11
    s_add_u32 s90, s90, s68
    s_lshl_b32 s90, s90, 2
    s_add_u32 s90, s90, 0x400000
    v_cvt_pk_bf16_f32 v36, v92, v93
    v_cvt_pk_bf16_f32 v37, v94, v95
    v_cvt_pk_bf16_f32 v38, v96, v97
    v_cvt_pk_bf16_f32 v39, v98, v99
    v_cvt_pk_bf16_f32 v40, v100, v101
    v_cvt_pk_bf16_f32 v41, v102, v103
    v_cvt_pk_bf16_f32 v42, v104, v105
    v_cvt_pk_bf16_f32 v43, v106, v107
    v_cvt_pk_bf16_f32 v44, v108, v109
    buffer_store_dwordx4 v[36:39], v126, s[16:19], s88 offen offset:256 sc1
    buffer_store_dwordx4 v[40:43], v126, s[16:19], s89 offen offset:256 sc1
    buffer_store_dword v44, v127, s[16:19], s90 offen offset:64 sc1
    ds_read_b128 v[128:131], v6 offset:0
    ds_read_b128 v[132:135], v6 offset:192
    ds_read_b128 v[136:139], v6 offset:384
    ds_read_b128 v[140:143], v6 offset:576
    ds_read_b128 v[144:147], v6 offset:768
    ds_read_b128 v[148:151], v6 offset:64
    ds_read_b128 v[152:155], v6 offset:256
    ds_read_b128 v[156:159], v6 offset:448
    ds_read_b128 v[160:163], v6 offset:640
    ds_read_b128 v[164:167], v6 offset:832
    s_waitcnt lgkmcnt(5)
    v_mfma_f32_16x16x32_bf16 v[92:95], v[128:131], v[80:83], 0
    v_mfma_f32_16x16x32_bf16 v[96:99], v[132:135], v[80:83], 0
    v_mfma_f32_16x16x32_bf16 v[100:103], v[136:139], v[80:83], 0
    v_mfma_f32_16x16x32_bf16 v[104:107], v[140:143], v[80:83], 0
    v_mfma_f32_16x16x32_bf16 v[108:111], v[144:147], v[80:83], 0
    ds_read_b128 v[128:131], v6 offset:128
    ds_read_b128 v[132:135], v6 offset:320
    ds_read_b128 v[136:139], v6 offset:512
    ds_read_b128 v[140:143], v6 offset:704
    ds_read_b128 v[144:147], v6 offset:896
    s_waitcnt lgkmcnt(5)
    v_mfma_f32_16x16x32_bf16 v[92:95], v[148:151], v[84:87], v[92:95]
    v_mfma_f32_16x16x32_bf16 v[96:99], v[152:155], v[84:87], v[96:99]
    v_mfma_f32_16x16x32_bf16 v[100:103], v[156:159], v[84:87], v[100:103]
    v_mfma_f32_16x16x32_bf16 v[104:107], v[160:163], v[84:87], v[104:107]
    v_mfma_f32_16x16x32_bf16 v[108:111], v[164:167], v[84:87], v[108:111]
    s_waitcnt lgkmcnt(0)
    v_mfma_f32_16x16x32_bf16 v[92:95], v[128:131], v[88:91], v[92:95]
    v_mfma_f32_16x16x32_bf16 v[96:99], v[132:135], v[88:91], v[96:99]
    v_mfma_f32_16x16x32_bf16 v[100:103], v[136:139], v[88:91], v[100:103]
    v_mfma_f32_16x16x32_bf16 v[104:107], v[140:143], v[88:91], v[104:107]
    v_mfma_f32_16x16x32_bf16 v[108:111], v[144:147], v[88:91], v[108:111]
    s_lshl_b32 s87, s61, 2
    s_lshl_b32 s67, s94, 5
    s_add_u32 s67, s67, 16
    v_add_u32 v12, s67, v3
    v_mul_u32_u24 v12, 296, v12
    v_mul_u32_u24 v13, 72, v2
    v_add_u32 v124, v12, v13
    v_add_u32 v124, 57344, v124
    v_max3_f32 v146, v92, v93, v94
    v_min3_f32 v148, v92, v93, v94
    v_max3_f32 v146, v146, v95, v96
    v_min3_f32 v148, v148, v95, v96
    v_max3_f32 v146, v146, v97, v98
    v_min3_f32 v148, v148, v97, v98
    v_max3_f32 v146, v146, v99, v100
    v_min3_f32 v148, v148, v99, v100
    v_max3_f32 v146, v146, v101, v102
    v_min3_f32 v148, v148, v101, v102
    v_max3_f32 v146, v146, v103, v104
    v_min3_f32 v148, v148, v103, v104
    v_max3_f32 v146, v146, v105, v106
    v_min3_f32 v148, v148, v105, v106
    v_max3_f32 v146, v146, v107, v108
    v_min3_f32 v148, v148, v107, v108
    v_max_f32 v146, v146, v109
    v_min_f32 v148, v148, v109
    v_mul_f32 v146, s72, v146
    v_mul_f32 v148, s72, v148
    v_pk_fma_f32 v[16:17], v[92:93], s[72:73], v[146:147] op_sel_hi:[1,1,0] neg_lo:[0,0,1] neg_hi:[0,0,1]
    v_pk_fma_f32 v[128:129], v[92:93], s[72:73], v[148:149] op_sel_hi:[1,1,0] neg_lo:[1,0,0] neg_hi:[1,0,0]
    v_pk_fma_f32 v[18:19], v[94:95], s[72:73], v[146:147] op_sel_hi:[1,1,0] neg_lo:[0,0,1] neg_hi:[0,0,1]
    v_pk_fma_f32 v[130:131], v[94:95], s[72:73], v[148:149] op_sel_hi:[1,1,0] neg_lo:[1,0,0] neg_hi:[1,0,0]
    v_pk_fma_f32 v[20:21], v[96:97], s[72:73], v[146:147] op_sel_hi:[1,1,0] neg_lo:[0,0,1] neg_hi:[0,0,1]
    v_pk_fma_f32 v[132:133], v[96:97], s[72:73], v[148:149] op_sel_hi:[1,1,0] neg_lo:[1,0,0] neg_hi:[1,0,0]
    v_pk_fma_f32 v[22:23], v[98:99], s[72:73], v[146:147] op_sel_hi:[1,1,0] neg_lo:[0,0,1] neg_hi:[0,0,1]
    v_pk_fma_f32 v[134:135], v[98:99], s[72:73], v[148:149] op_sel_hi:[1,1,0] neg_lo:[1,0,0] neg_hi:[1,0,0]
    v_pk_fma_f32 v[24:25], v[100:101], s[72:73], v[146:147] op_sel_hi:[1,1,0] neg_lo:[0,0,1] neg_hi:[0,0,1]
    v_pk_fma_f32 v[136:137], v[100:101], s[72:73], v[148:149] op_sel_hi:[1,1,0] neg_lo:[1,0,0] neg_hi:[1,0,0]
    v_pk_fma_f32 v[26:27], v[102:103], s[72:73], v[146:147] op_sel_hi:[1,1,0] neg_lo:[0,0,1] neg_hi:[0,0,1]
    v_pk_fma_f32 v[138:139], v[102:103], s[72:73], v[148:149] op_sel_hi:[1,1,0] neg_lo:[1,0,0] neg_hi:[1,0,0]
    v_pk_fma_f32 v[28:29], v[104:105], s[72:73], v[146:147] op_sel_hi:[1,1,0] neg_lo:[0,0,1] neg_hi:[0,0,1]
    v_pk_fma_f32 v[140:141], v[104:105], s[72:73], v[148:149] op_sel_hi:[1,1,0] neg_lo:[1,0,0] neg_hi:[1,0,0]
    v_pk_fma_f32 v[30:31], v[106:107], s[72:73], v[146:147] op_sel_hi:[1,1,0] neg_lo:[0,0,1] neg_hi:[0,0,1]
    v_pk_fma_f32 v[142:143], v[106:107], s[72:73], v[148:149] op_sel_hi:[1,1,0] neg_lo:[1,0,0] neg_hi:[1,0,0]
    v_pk_fma_f32 v[32:33], v[108:109], s[72:73], v[146:147] op_sel_hi:[1,1,0] neg_lo:[0,0,1] neg_hi:[0,0,1]
    v_pk_fma_f32 v[144:145], v[108:109], s[72:73], v[148:149] op_sel_hi:[1,1,0] neg_lo:[1,0,0] neg_hi:[1,0,0]
    v_exp_f32 v16, v16
    v_exp_f32 v128, v128
    v_exp_f32 v17, v17
    v_exp_f32 v129, v129
    v_exp_f32 v18, v18
    v_exp_f32 v130, v130
    v_exp_f32 v19, v19
    v_exp_f32 v131, v131
    v_exp_f32 v20, v20
    v_exp_f32 v132, v132
    v_exp_f32 v21, v21
    v_exp_f32 v133, v133
    v_exp_f32 v22, v22
    v_exp_f32 v134, v134
    v_exp_f32 v23, v23
    v_exp_f32 v135, v135
    v_exp_f32 v24, v24
    v_exp_f32 v136, v136
    v_exp_f32 v25, v25
    v_exp_f32 v137, v137
    v_exp_f32 v26, v26
    v_exp_f32 v138, v138
    v_exp_f32 v27, v27
    v_exp_f32 v139, v139
    v_exp_f32 v28, v28
    v_exp_f32 v140, v140
    v_exp_f32 v29, v29
    v_exp_f32 v141, v141
    v_exp_f32 v30, v30
    v_exp_f32 v142, v142
    v_exp_f32 v31, v31
    v_exp_f32 v143, v143
    v_exp_f32 v32, v32
    v_exp_f32 v144, v144
    v_exp_f32 v33, v33
    v_exp_f32 v145, v145
    v_pk_add_f32 v[150:151], v[16:17], v[18:19]
    v_pk_add_f32 v[150:151], v[150:151], v[20:21]
    v_pk_add_f32 v[150:151], v[150:151], v[22:23]
    v_pk_add_f32 v[150:151], v[150:151], v[24:25]
    v_pk_add_f32 v[150:151], v[150:151], v[26:27]
    v_pk_add_f32 v[150:151], v[150:151], v[28:29]
    v_pk_add_f32 v[150:151], v[150:151], v[30:31]
    v_pk_add_f32 v[150:151], v[150:151], v[32:33]
    v_add_f32 v150, v150, v151
    v_rcp_f32 v150, v150
    s_nop 0
    v_pk_mul_f32 v[16:17], v[16:17], v[150:151] op_sel_hi:[1,0]
    v_pk_mul_f32 v[18:19], v[18:19], v[150:151] op_sel_hi:[1,0]
    v_pk_mul_f32 v[20:21], v[20:21], v[150:151] op_sel_hi:[1,0]
    v_pk_mul_f32 v[22:23], v[22:23], v[150:151] op_sel_hi:[1,0]
    v_pk_mul_f32 v[24:25], v[24:25], v[150:151] op_sel_hi:[1,0]
    v_pk_mul_f32 v[26:27], v[26:27], v[150:151] op_sel_hi:[1,0]
    v_pk_mul_f32 v[28:29], v[28:29], v[150:151] op_sel_hi:[1,0]
    v_pk_mul_f32 v[30:31], v[30:31], v[150:151] op_sel_hi:[1,0]
    v_pk_mul_f32 v[32:33], v[32:33], v[150:151] op_sel_hi:[1,0]
    v_pk_add_f32 v[150:151], v[128:129], v[130:131]
    v_pk_add_f32 v[150:151], v[150:151], v[132:133]
    v_pk_add_f32 v[150:151], v[150:151], v[134:135]
    v_pk_add_f32 v[150:151], v[150:151], v[136:137]
    v_pk_add_f32 v[150:151], v[150:151], v[138:139]
    v_pk_add_f32 v[150:151], v[150:151], v[140:141]
    v_pk_add_f32 v[150:151], v[150:151], v[142:143]
    v_pk_add_f32 v[150:151], v[150:151], v[144:145]
    v_add_f32 v150, v150, v151
    v_rcp_f32 v150, v150
    s_nop 0
    v_pk_mul_f32 v[128:129], v[128:129], v[150:151] op_sel_hi:[1,0]
    v_pk_mul_f32 v[130:131], v[130:131], v[150:151] op_sel_hi:[1,0]
    v_pk_mul_f32 v[132:133], v[132:133], v[150:151] op_sel_hi:[1,0]
    v_pk_mul_f32 v[134:135], v[134:135], v[150:151] op_sel_hi:[1,0]
    v_pk_mul_f32 v[136:137], v[136:137], v[150:151] op_sel_hi:[1,0]
    v_pk_mul_f32 v[138:139], v[138:139], v[150:151] op_sel_hi:[1,0]
    v_pk_mul_f32 v[140:141], v[140:141], v[150:151] op_sel_hi:[1,0]
    v_pk_mul_f32 v[142:143], v[142:143], v[150:151] op_sel_hi:[1,0]
    v_pk_mul_f32 v[144:145], v[144:145], v[150:151] op_sel_hi:[1,0]
    v_cvt_pk_bf16_f32 v92, v16, v17
    v_cvt_pk_bf16_f32 v101, v128, v129
    v_cvt_pk_bf16_f32 v93, v18, v19
    v_cvt_pk_bf16_f32 v102, v130, v131
    v_cvt_pk_bf16_f32 v94, v20, v21
    v_cvt_pk_bf16_f32 v103, v132, v133
    v_cvt_pk_bf16_f32 v95, v22, v23
    v_cvt_pk_bf16_f32 v104, v134, v135
    v_cvt_pk_bf16_f32 v96, v24, v25
    v_cvt_pk_bf16_f32 v105, v136, v137
    v_cvt_pk_bf16_f32 v97, v26, v27
    v_cvt_pk_bf16_f32 v106, v138, v139
    v_cvt_pk_bf16_f32 v98, v28, v29
    v_cvt_pk_bf16_f32 v107, v140, v141
    v_cvt_pk_bf16_f32 v99, v30, v31
    v_cvt_pk_bf16_f32 v108, v142, v143
    v_cvt_pk_bf16_f32 v100, v32, v33
    v_cvt_pk_bf16_f32 v109, v144, v145
    ds_write_b64 v124, v[92:93] offset:0
    ds_write_b64 v124, v[94:95] offset:8
    ds_write_b64 v124, v[96:97] offset:16
    ds_write_b64 v124, v[98:99] offset:24
    ds_write_b64 v124, v[100:101] offset:32
    ds_write_b64 v124, v[102:103] offset:40
    ds_write_b64 v124, v[104:105] offset:48
    ds_write_b64 v124, v[106:107] offset:56
    ds_write_b64 v124, v[108:109] offset:64
    s_mul_i32 s67, s94, 5120
    s_add_u32 s67, s67, 100352
    v_lshl_add_u32 v125, v1, 4, s67
    v_cvt_pk_bf16_f32 v152, v56, v57
    v_cvt_pk_bf16_f32 v153, v58, v59
    v_cvt_pk_bf16_f32 v154, v60, v61
    v_cvt_pk_bf16_f32 v155, v62, v63
    ds_write_b128 v125, v[152:155] offset:1024
    v_cvt_pk_bf16_f32 v156, v64, v65
    v_cvt_pk_bf16_f32 v157, v66, v67
    v_cvt_pk_bf16_f32 v158, v68, v69
    v_cvt_pk_bf16_f32 v159, v70, v71
    ds_write_b128 v125, v[156:159] offset:2048
    v_cvt_pk_bf16_f32 v160, v72, v73
    v_cvt_pk_bf16_f32 v161, v74, v75
    v_cvt_pk_bf16_f32 v162, v76, v77
    v_cvt_pk_bf16_f32 v163, v78, v79
    ds_write_b128 v125, v[160:163] offset:3072
    s_waitcnt lgkmcnt(0)
    s_barrier
    v_lshl_add_u32 v12, v2, 2, v4
    v_mul_u32_u24 v12, 296, v12
    v_lshl_add_u32 v12, v5, 3, v12
    s_mul_i32 s67, s94, 72
    s_add_u32 s67, s67, 57344
    v_add_u32 v124, s67, v12
    s_mov_b32 s67, 104448
    v_lshl_add_u32 v125, v1, 4, s67
    ds_read_b64_tr_b16 v[28:29], v124 offset:0
    ds_read_b64_tr_b16 v[30:31], v124 offset:4736
    ds_read_b64_tr_b16 v[32:33], v124 offset:32
    ds_read_b64_tr_b16 v[34:35], v124 offset:4768
    ds_read_b64_tr_b16 v[36:37], v124 offset:64
    ds_read_b64_tr_b16 v[38:39], v124 offset:4800
    ds_read_b128 v[76:79], v125 offset:0
    ds_read_b64_tr_b16 v[40:41], v124 offset:9472
    ds_read_b64_tr_b16 v[42:43], v124 offset:14208
    ds_read_b64_tr_b16 v[44:45], v124 offset:9504
    ds_read_b64_tr_b16 v[46:47], v124 offset:14240
    ds_read_b64_tr_b16 v[48:49], v124 offset:9536
    ds_read_b64_tr_b16 v[50:51], v124 offset:14272
    ds_read_b128 v[80:83], v125 offset:5120
    s_waitcnt lgkmcnt(7)
    v_mfma_f32_16x16x32_bf16 v[16:19], v[28:31], v[76:79], 0
    v_mfma_f32_16x16x32_bf16 v[20:23], v[32:35], v[76:79], 0
    v_mfma_f32_16x16x32_bf16 v[24:27], v[36:39], v[76:79], 0
    ds_read_b64_tr_b16 v[52:53], v124 offset:18944
    ds_read_b64_tr_b16 v[54:55], v124 offset:23680
    ds_read_b64_tr_b16 v[56:57], v124 offset:18976
    ds_read_b64_tr_b16 v[58:59], v124 offset:23712
    ds_read_b64_tr_b16 v[60:61], v124 offset:19008
    ds_read_b64_tr_b16 v[62:63], v124 offset:23744
    ds_read_b128 v[84:87], v125 offset:10240
    s_waitcnt lgkmcnt(7)
    v_mfma_f32_16x16x32_bf16 v[16:19], v[40:43], v[80:83], v[16:19]
    v_mfma_f32_16x16x32_bf16 v[20:23], v[44:47], v[80:83], v[20:23]
    v_mfma_f32_16x16x32_bf16 v[24:27], v[48:51], v[80:83], v[24:27]
    ds_read_b64_tr_b16 v[64:65], v124 offset:28416
    ds_read_b64_tr_b16 v[66:67], v124 offset:33152
    ds_read_b64_tr_b16 v[68:69], v124 offset:28448
    ds_read_b64_tr_b16 v[70:71], v124 offset:33184
    ds_read_b64_tr_b16 v[72:73], v124 offset:28480
    ds_read_b64_tr_b16 v[74:75], v124 offset:33216
    ds_read_b128 v[88:91], v125 offset:15360
    s_waitcnt lgkmcnt(7)
    v_mfma_f32_16x16x32_bf16 v[16:19], v[52:55], v[84:87], v[16:19]
    v_mfma_f32_16x16x32_bf16 v[20:23], v[56:59], v[84:87], v[20:23]
    v_mfma_f32_16x16x32_bf16 v[24:27], v[60:63], v[84:87], v[24:27]
    s_and_b32 s85, s94, 1
    s_lshl_b32 s85, s85, 1
    v_mul_u32_u24 v12, 20, v2
    v_mov_b32 v14, s75
    s_cmp_eq_u32 s85, 0
    s_cselect_b32 s67, 16, 0
    v_and_b32 v13, 1, v3
    v_add_u32 v13, s67, v13
    v_mov_b32 v15, 18
    v_cmp_eq_u32 vcc, 8, v3
    s_nop 1
    v_cndmask_b32 v13, v13, v15, vcc
    v_add_u32 v13, v13, v12
    v_lshlrev_b32 v13, 4, v13
    v_lshrrev_b32 v15, 1, v3
    v_cmp_eq_u32 s[92:93], s94, v15
    s_nop 0
    s_or_b64 vcc, vcc, s[92:93]
    v_cndmask_b32 v126, v14, v13, vcc
    v_cmp_eq_u32 vcc, 0, v2
    s_nop 1
    v_cndmask_b32 v127, v14, v126, vcc
    s_add_u32 s67, s87, s94
    s_lshl_b32 s67, s67, 4
    s_add_u32 s67, s67, s60
    s_mul_i32 s67, s67, 3072
    s_add_u32 s67, s67, 0x500000
    s_waitcnt lgkmcnt(0)
    v_mfma_f32_16x16x32_bf16 v[16:19], v[64:67], v[88:91], v[16:19]
    v_mfma_f32_16x16x32_bf16 v[20:23], v[68:71], v[88:91], v[20:23]
    v_mfma_f32_16x16x32_bf16 v[24:27], v[72:75], v[88:91], v[24:27]
    s_nop 5
    buffer_store_dwordx4 v[16:19], v126, s[16:19], s67 offen offset:0 sc1
    buffer_store_dwordx4 v[20:23], v126, s[16:19], s67 offen offset:1280 sc1
    buffer_store_dwordx4 v[24:27], v127, s[16:19], s67 offen offset:2560 sc1
    s_endpgm
K1_LOADER:
    v_lshrrev_b32 v8, 3, v1
    v_and_b32 v9, 7, v1
    v_lshrrev_b32 v10, 1, v8
    v_xor_b32 v9, v9, v10
    v_mul_u32_u24 v8, 1152, v8
    v_lshl_add_u32 v17, v9, 4, v8
    v_xor_b32 v18, 64, v17
    s_lshl_b32 s70, s60, 7
    s_lshl_b32 s67, s94, 5
    s_add_u32 s70, s70, s67
    s_mul_i32 s70, s70, 1152
    s_lshl_b32 s71, s94, 12
    s_add_u32 s71, s71, 100352
    s_mov_b32 s74, 0x6620cc
    s_mul_i32 s69, s63, 144
    s_and_b32 s67, s94, 1
    v_cmp_le_u32 vcc, 28, v1
    s_nop 1
    v_cndmask_b32 v8, 0, 1, vcc
    v_mul_u32_u24 v9, 28, v8
    v_sub_u32 v9, v1, v9
    v_subrev_u32 v9, s67, v9
    v_mul_u32_u24 v10, 57, v9
    v_lshrrev_b32 v10, 9, v10
    v_mul_u32_u24 v11, 9, v10
    v_sub_u32 v11, v9, v11
    v_mul_u32_u24 v12, 3, v11
    v_lshrrev_b32 v12, v12, s74
    v_and_b32 v12, 7, v12
    v_add3_u32 v12, v12, v11, -2
    v_cmp_eq_u32 vcc, 2, v10
    s_nop 1
    v_cndmask_b32 v11, v11, v12, vcc
    v_mul_u32_u24 v8, 3456, v8
    v_mul_u32_u24 v10, 1152, v10
    v_lshl_add_u32 v11, v11, 4, v8
    v_add3_u32 v11, v11, v10, s69
    v_cmp_lt_u32 vcc, 26, v9
    v_mov_b32 v12, s75
    s_nop 0
    v_cndmask_b32 v16, v11, v12, vcc
    s_mul_i32 s77, s94, 8*448
    s_mul_i32 s78, s94, 8*3456
    s_mov_b32 s80, -1
    s_mov_b32 s81, 0x00ffffff
    s_waitcnt lgkmcnt(0)
    s_mov_b32 s8, s36
    s_and_b32 s9, s37, 0xffff
    s_mov_b32 s10, 0x240000
    s_mov_b32 s11, 0x20000
    s_cmp_eq_u32 s62, 0
    s_cselect_b64 s[4:5], s[38:39], s[46:47]
    s_cselect_b64 s[6:7], s[40:41], s[48:49]
    s_mov_b32 s12, s4
    s_and_b32 s13, s5, 0xffff
    s_mov_b32 s14, 0x1e6000
    s_mov_b32 s15, 0x20000
    s_add_u32 m0, s71, 0
    s_add_u32 s76, s70, 0
    buffer_load_dwordx4 v17, s[8:11], s76 offen lds
    s_add_u32 m0, s71, 1024
    s_add_u32 s76, s70, 9216
    buffer_load_dwordx4 v18, s[8:11], s76 offen lds
    s_add_u32 m0, s71, 2048
    s_add_u32 s76, s70, 18432
    buffer_load_dwordx4 v17, s[8:11], s76 offen lds
    s_add_u32 m0, s71, 3072
    s_add_u32 s76, s70, 27648
    buffer_load_dwordx4 v18, s[8:11], s76 offen lds
    s_mov_b64 exec, s[80:81]
    s_add_u32 m0, s77, 0
    s_add_u32 s76, s78, 0
    buffer_load_dwordx4 v16, s[12:15], s76 offen lds
    s_add_u32 m0, s77, 896
    s_add_u32 s76, s78, 6912
    buffer_load_dwordx4 v16, s[12:15], s76 offen lds
    s_add_u32 m0, s77, 1792
    s_add_u32 s76, s78, 13824
    buffer_load_dwordx4 v16, s[12:15], s76 offen lds
    s_add_u32 m0, s77, 2688
    s_add_u32 s76, s78, 20736
    buffer_load_dwordx4 v16, s[12:15], s76 offen lds
    s_mov_b64 exec, -1
    s_mov_b64 exec, s[80:81]
    s_add_u32 m0, s77, 14336
    s_add_u32 s76, s78, 110592
    buffer_load_dwordx4 v16, s[12:15], s76 offen lds
    s_add_u32 m0, s77, 15232
    s_add_u32 s76, s78, 117504
    buffer_load_dwordx4 v16, s[12:15], s76 offen lds
    s_add_u32 m0, s77, 16128
    s_add_u32 s76, s78, 124416
    buffer_load_dwordx4 v16, s[12:15], s76 offen lds
    s_add_u32 m0, s77, 17024
    s_add_u32 s76, s78, 131328
    buffer_load_dwordx4 v16, s[12:15], s76 offen lds
    s_mov_b64 exec, -1
    s_add_u32 m0, s71, 16384
    s_add_u32 s76, s70, 128
    buffer_load_dwordx4 v17, s[8:11], s76 offen lds
    s_add_u32 m0, s71, 17408
    s_add_u32 s76, s70, 9344
    buffer_load_dwordx4 v18, s[8:11], s76 offen lds
    s_add_u32 m0, s71, 18432
    s_add_u32 s76, s70, 18560
    buffer_load_dwordx4 v17, s[8:11], s76 offen lds
    s_add_u32 m0, s71, 19456
    s_add_u32 s76, s70, 27776
    buffer_load_dwordx4 v18, s[8:11], s76 offen lds
    s_mov_b64 exec, s[80:81]
    s_add_u32 m0, s77, 28672
    s_add_u32 s76, s78, 221184
    buffer_load_dwordx4 v16, s[12:15], s76 offen lds
    s_add_u32 m0, s77, 29568
    s_add_u32 s76, s78, 228096
    buffer_load_dwordx4 v16, s[12:15], s76 offen lds
    s_add_u32 m0, s77, 30464
    s_add_u32 s76, s78, 235008
    buffer_load_dwordx4 v16, s[12:15], s76 offen lds
    s_add_u32 m0, s77, 31360
    s_add_u32 s76, s78, 241920
    buffer_load_dwordx4 v16, s[12:15], s76 offen lds
    s_mov_b64 exec, -1
    s_mov_b32 s16, s58
    s_and_b32 s17, s59, 0xffff
    s_mov_b32 s18, 0x2000000
    s_mov_b32 s19, 0x20000
    s_mov_b32 s28, s52
    s_and_b32 s29, s53, 0xffff
    s_mov_b32 s30, 0x480
    s_mov_b32 s31, 0x20000
    s_waitcnt vmcnt(12)
    s_barrier
    s_mov_b64 exec, s[80:81]
    s_add_u32 m0, s77, 43008
    s_add_u32 s76, s78, 331776
    buffer_load_dwordx4 v16, s[12:15], s76 offen lds
    s_add_u32 m0, s77, 43904
    s_add_u32 s76, s78, 338688
    buffer_load_dwordx4 v16, s[12:15], s76 offen lds
    s_add_u32 m0, s77, 44800
    s_add_u32 s76, s78, 345600
    buffer_load_dwordx4 v16, s[12:15], s76 offen lds
    s_add_u32 m0, s77, 45696
    s_add_u32 s76, s78, 352512
    buffer_load_dwordx4 v16, s[12:15], s76 offen lds
    s_mov_b64 exec, -1
    s_mov_b64 exec, s[80:81]
    s_add_u32 m0, s77, 57344
    s_add_u32 s76, s78, 442368
    buffer_load_dwordx4 v16, s[12:15], s76 offen lds
    s_add_u32 m0, s77, 58240
    s_add_u32 s76, s78, 449280
    buffer_load_dwordx4 v16, s[12:15], s76 offen lds
    s_add_u32 m0, s77, 59136
    s_add_u32 s76, s78, 456192
    buffer_load_dwordx4 v16, s[12:15], s76 offen lds
    s_add_u32 m0, s77, 60032
    s_add_u32 s76, s78, 463104
    buffer_load_dwordx4 v16, s[12:15], s76 offen lds
    s_mov_b64 exec, -1
    s_add_u32 m0, s71, 32768
    s_add_u32 s76, s70, 256
    buffer_load_dwordx4 v17, s[8:11], s76 offen lds
    s_add_u32 m0, s71, 33792
    s_add_u32 s76, s70, 9472
    buffer_load_dwordx4 v18, s[8:11], s76 offen lds
    s_waitcnt vmcnt(18)
    s_barrier
    s_mov_b64 exec, s[80:81]
    s_add_u32 m0, s77, 71680
    s_add_u32 s76, s78, 552960
    buffer_load_dwordx4 v16, s[12:15], s76 offen lds
    s_add_u32 m0, s77, 72576
    s_add_u32 s76, s78, 559872
    buffer_load_dwordx4 v16, s[12:15], s76 offen lds
    s_add_u32 m0, s77, 73472
    s_add_u32 s76, s78, 566784
    buffer_load_dwordx4 v16, s[12:15], s76 offen lds
    s_add_u32 m0, s77, 74368
    s_add_u32 s76, s78, 573696
    buffer_load_dwordx4 v16, s[12:15], s76 offen lds
    s_mov_b64 exec, -1
    s_add_u32 m0, s71, 34816
    s_add_u32 s76, s70, 18688
    buffer_load_dwordx4 v17, s[8:11], s76 offen lds
    s_add_u32 m0, s71, 35840
    s_add_u32 s76, s70, 27904
    buffer_load_dwordx4 v18, s[8:11], s76 offen lds
    s_waitcnt vmcnt(16)
    s_barrier
    s_mov_b64 exec, s[80:81]
    s_add_u32 m0, s77, 86016
    s_add_u32 s76, s78, 663552
    buffer_load_dwordx4 v16, s[12:15], s76 offen lds
    s_add_u32 m0, s77, 86912
    s_add_u32 s76, s78, 670464
    buffer_load_dwordx4 v16, s[12:15], s76 offen lds
    s_add_u32 m0, s77, 87808
    s_add_u32 s76, s78, 677376
    buffer_load_dwordx4 v16, s[12:15], s76 offen lds
    s_add_u32 m0, s77, 88704
    s_add_u32 s76, s78, 684288
    buffer_load_dwordx4 v16, s[12:15], s76 offen lds
    s_mov_b64 exec, -1
    s_add_u32 m0, s71, 0
    s_add_u32 s76, s70, 384
    buffer_load_dwordx4 v17, s[8:11], s76 offen lds
    s_add_u32 m0, s71, 1024
    s_add_u32 s76, s70, 9600
    buffer_load_dwordx4 v18, s[8:11], s76 offen lds
    s_waitcnt vmcnt(18)
    s_barrier
    s_mov_b64 exec, s[80:81]
    s_add_u32 m0, s77, 0
    s_add_u32 s76, s78, 774144
    buffer_load_dwordx4 v16, s[12:15], s76 offen lds
    s_add_u32 m0, s77, 896
    s_add_u32 s76, s78, 781056
    buffer_load_dwordx4 v16, s[12:15], s76 offen lds
    s_add_u32 m0, s77, 1792
    s_add_u32 s76, s78, 787968
    buffer_load_dwordx4 v16, s[12:15], s76 offen lds
    s_add_u32 m0, s77, 2688
    s_add_u32 s76, s78, 794880
    buffer_load_dwordx4 v16, s[12:15], s76 offen lds
    s_mov_b64 exec, -1
    s_add_u32 m0, s71, 2048
    s_add_u32 s76, s70, 18816
    buffer_load_dwordx4 v17, s[8:11], s76 offen lds
    s_add_u32 m0, s71, 3072
    s_add_u32 s76, s70, 28032
    buffer_load_dwordx4 v18, s[8:11], s76 offen lds
    s_waitcnt vmcnt(20)
    s_waitcnt vmcnt(12)
    s_barrier
    s_mov_b64 exec, s[80:81]
    s_add_u32 m0, s77, 14336
    s_add_u32 s76, s78, 884736
    buffer_load_dwordx4 v16, s[12:15], s76 offen lds
    s_add_u32 m0, s77, 15232
    s_add_u32 s76, s78, 891648
    buffer_load_dwordx4 v16, s[12:15], s76 offen lds
    s_add_u32 m0, s77, 16128
    s_add_u32 s76, s78, 898560
    buffer_load_dwordx4 v16, s[12:15], s76 offen lds
    s_add_u32 m0, s77, 17024
    s_add_u32 s76, s78, 905472
    buffer_load_dwordx4 v16, s[12:15], s76 offen lds
    s_mov_b64 exec, -1
    s_add_u32 m0, s71, 16384
    s_add_u32 s76, s70, 512
    buffer_load_dwordx4 v17, s[8:11], s76 offen lds
    s_add_u32 m0, s71, 17408
    s_add_u32 s76, s70, 9728
    buffer_load_dwordx4 v18, s[8:11], s76 offen lds
    s_barrier
    s_mov_b64 exec, s[80:81]
    s_add_u32 m0, s77, 28672
    s_add_u32 s76, s78, 995328
    buffer_load_dwordx4 v16, s[12:15], s76 offen lds
    s_add_u32 m0, s77, 29568
    s_add_u32 s76, s78, 1002240
    buffer_load_dwordx4 v16, s[12:15], s76 offen lds
    s_add_u32 m0, s77, 30464
    s_add_u32 s76, s78, 1009152
    buffer_load_dwordx4 v16, s[12:15], s76 offen lds
    s_add_u32 m0, s77, 31360
    s_add_u32 s76, s78, 1016064
    buffer_load_dwordx4 v16, s[12:15], s76 offen lds
    s_mov_b64 exec, -1
    s_add_u32 m0, s71, 18432
    s_add_u32 s76, s70, 18944
    buffer_load_dwordx4 v17, s[8:11], s76 offen lds
    s_add_u32 m0, s71, 19456
    s_add_u32 s76, s70, 28160
    buffer_load_dwordx4 v18, s[8:11], s76 offen lds
    s_waitcnt vmcnt(20)
    s_waitcnt vmcnt(12)
    s_barrier
    s_mov_b64 exec, s[80:81]
    s_add_u32 m0, s77, 43008
    s_add_u32 s76, s78, 1105920
    buffer_load_dwordx4 v16, s[12:15], s76 offen lds
    s_add_u32 m0, s77, 43904
    s_add_u32 s76, s78, 1112832
    buffer_load_dwordx4 v16, s[12:15], s76 offen lds
    s_add_u32 m0, s77, 44800
    s_add_u32 s76, s78, 1119744
    buffer_load_dwordx4 v16, s[12:15], s76 offen lds
    s_add_u32 m0, s77, 45696
    s_add_u32 s76, s78, 1126656
    buffer_load_dwordx4 v16, s[12:15], s76 offen lds
    s_mov_b64 exec, -1
    s_add_u32 m0, s71, 32768
    s_add_u32 s76, s70, 640
    buffer_load_dwordx4 v17, s[8:11], s76 offen lds
    s_add_u32 m0, s71, 33792
    s_add_u32 s76, s70, 9856
    buffer_load_dwordx4 v18, s[8:11], s76 offen lds
    s_barrier
    s_mov_b64 exec, s[80:81]
    s_add_u32 m0, s77, 57344
    s_add_u32 s76, s78, 1216512
    buffer_load_dwordx4 v16, s[12:15], s76 offen lds
    s_add_u32 m0, s77, 58240
    s_add_u32 s76, s78, 1223424
    buffer_load_dwordx4 v16, s[12:15], s76 offen lds
    s_add_u32 m0, s77, 59136
    s_add_u32 s76, s78, 1230336
    buffer_load_dwordx4 v16, s[12:15], s76 offen lds
    s_add_u32 m0, s77, 60032
    s_add_u32 s76, s78, 1237248
    buffer_load_dwordx4 v16, s[12:15], s76 offen lds
    s_mov_b64 exec, -1
    s_add_u32 m0, s71, 34816
    s_add_u32 s76, s70, 19072
    buffer_load_dwordx4 v17, s[8:11], s76 offen lds
    s_add_u32 m0, s71, 35840
    s_add_u32 s76, s70, 28288
    buffer_load_dwordx4 v18, s[8:11], s76 offen lds
    s_waitcnt vmcnt(20)
    s_waitcnt vmcnt(12)
    s_barrier
    s_mov_b64 exec, s[80:81]
    s_add_u32 m0, s77, 71680
    s_add_u32 s76, s78, 1327104
    buffer_load_dwordx4 v16, s[12:15], s76 offen lds
    s_add_u32 m0, s77, 72576
    s_add_u32 s76, s78, 1334016
    buffer_load_dwordx4 v16, s[12:15], s76 offen lds
    s_add_u32 m0, s77, 73472
    s_add_u32 s76, s78, 1340928
    buffer_load_dwordx4 v16, s[12:15], s76 offen lds
    s_add_u32 m0, s77, 74368
    s_add_u32 s76, s78, 1347840
    buffer_load_dwordx4 v16, s[12:15], s76 offen lds
    s_mov_b64 exec, -1
    s_add_u32 m0, s71, 0
    s_add_u32 s76, s70, 768
    buffer_load_dwordx4 v17, s[8:11], s76 offen lds
    s_add_u32 m0, s71, 1024
    s_add_u32 s76, s70, 9984
    buffer_load_dwordx4 v18, s[8:11], s76 offen lds
    s_barrier
    s_mov_b64 exec, s[80:81]
    s_add_u32 m0, s77, 86016
    s_add_u32 s76, s78, 1437696
    buffer_load_dwordx4 v16, s[12:15], s76 offen lds
    s_add_u32 m0, s77, 86912
    s_add_u32 s76, s78, 1444608
    buffer_load_dwordx4 v16, s[12:15], s76 offen lds
    s_add_u32 m0, s77, 87808
    s_add_u32 s76, s78, 1451520
    buffer_load_dwordx4 v16, s[12:15], s76 offen lds
    s_add_u32 m0, s77, 88704
    s_add_u32 s76, s78, 1458432
    buffer_load_dwordx4 v16, s[12:15], s76 offen lds
    s_mov_b64 exec, -1
    s_add_u32 m0, s71, 2048
    s_add_u32 s76, s70, 19200
    buffer_load_dwordx4 v17, s[8:11], s76 offen lds
    s_add_u32 m0, s71, 3072
    s_add_u32 s76, s70, 28416
    buffer_load_dwordx4 v18, s[8:11], s76 offen lds
    s_waitcnt vmcnt(20)
    s_waitcnt vmcnt(12)
    s_barrier
    s_mov_b64 exec, s[80:81]
    s_add_u32 m0, s77, 0
    s_add_u32 s76, s78, 1548288
    buffer_load_dwordx4 v16, s[12:15], s76 offen lds
    s_add_u32 m0, s77, 896
    s_add_u32 s76, s78, 1555200
    buffer_load_dwordx4 v16, s[12:15], s76 offen lds
    s_add_u32 m0, s77, 1792
    s_add_u32 s76, s78, 1562112
    buffer_load_dwordx4 v16, s[12:15], s76 offen lds
    s_add_u32 m0, s77, 2688
    s_add_u32 s76, s78, 1569024
    buffer_load_dwordx4 v16, s[12:15], s76 offen lds
    s_mov_b64 exec, -1
    s_add_u32 m0, s71, 16384
    s_add_u32 s76, s70, 896
    buffer_load_dwordx4 v17, s[8:11], s76 offen lds
    s_add_u32 m0, s71, 17408
    s_add_u32 s76, s70, 10112
    buffer_load_dwordx4 v18, s[8:11], s76 offen lds
    s_barrier
    s_mov_b64 exec, s[80:81]
    s_add_u32 m0, s77, 14336
    s_add_u32 s76, s78, 1658880
    buffer_load_dwordx4 v16, s[12:15], s76 offen lds
    s_add_u32 m0, s77, 15232
    s_add_u32 s76, s78, 1665792
    buffer_load_dwordx4 v16, s[12:15], s76 offen lds
    s_add_u32 m0, s77, 16128
    s_add_u32 s76, s78, 1672704
    buffer_load_dwordx4 v16, s[12:15], s76 offen lds
    s_add_u32 m0, s77, 17024
    s_add_u32 s76, s78, 1679616
    buffer_load_dwordx4 v16, s[12:15], s76 offen lds
    s_mov_b64 exec, -1
    s_add_u32 m0, s71, 18432
    s_add_u32 s76, s70, 19328
    buffer_load_dwordx4 v17, s[8:11], s76 offen lds
    s_add_u32 m0, s71, 19456
    s_add_u32 s76, s70, 28544
    buffer_load_dwordx4 v18, s[8:11], s76 offen lds
    s_waitcnt vmcnt(20)
    s_waitcnt vmcnt(12)
    s_barrier
    s_mov_b64 exec, s[80:81]
    s_add_u32 m0, s77, 28672
    s_add_u32 s76, s78, 1769472
    buffer_load_dwordx4 v16, s[12:15], s76 offen lds
    s_add_u32 m0, s77, 29568
    s_add_u32 s76, s78, 1776384
    buffer_load_dwordx4 v16, s[12:15], s76 offen lds
    s_add_u32 m0, s77, 30464
    s_add_u32 s76, s78, 1783296
    buffer_load_dwordx4 v16, s[12:15], s76 offen lds
    s_add_u32 m0, s77, 31360
    s_add_u32 s76, s78, 1790208
    buffer_load_dwordx4 v16, s[12:15], s76 offen lds
    s_mov_b64 exec, -1
    s_add_u32 m0, s71, 32768
    s_add_u32 s76, s70, 1024
    buffer_load_dwordx4 v17, s[8:11], s76 offen lds
    s_add_u32 m0, s71, 33792
    s_add_u32 s76, s70, 10240
    buffer_load_dwordx4 v18, s[8:11], s76 offen lds
    s_barrier
    s_mov_b64 exec, s[80:81]
    s_add_u32 m0, s77, 43008
    s_add_u32 s76, s78, 1880064
    buffer_load_dwordx4 v16, s[12:15], s76 offen lds
    s_add_u32 m0, s77, 43904
    s_add_u32 s76, s78, 1886976
    buffer_load_dwordx4 v16, s[12:15], s76 offen lds
    s_add_u32 m0, s77, 44800
    s_add_u32 s76, s78, 1893888
    buffer_load_dwordx4 v16, s[12:15], s76 offen lds
    s_add_u32 m0, s77, 45696
    s_add_u32 s76, s78, 1900800
    buffer_load_dwordx4 v16, s[12:15], s76 offen lds
    s_mov_b64 exec, -1
    s_add_u32 m0, s71, 34816
    s_add_u32 s76, s70, 19456
    buffer_load_dwordx4 v17, s[8:11], s76 offen lds
    s_add_u32 m0, s71, 35840
    s_add_u32 s76, s70, 28672
    buffer_load_dwordx4 v18, s[8:11], s76 offen lds
    s_waitcnt vmcnt(20)
    s_waitcnt vmcnt(12)
    s_barrier
    s_barrier
    s_waitcnt vmcnt(8)
    s_waitcnt vmcnt(0)
    s_barrier
    s_barrier
    s_lshl_b32 s79, s60, 7
    s_lshl_b32 s67, s61, 3
    s_add_u32 s79, s79, s67
    s_lshl_b32 s67, s94, 1
    s_add_u32 s79, s79, s67
    v_lshrrev_b32 v8, 5, v1
    v_add_u32 v8, s79, v8
    v_and_b32 v9, 31, v1
    v_mul_u32_u24 v10, 36, v9
    v_mul_u32_u24 v11, 1152, v8
    v_add_u32 v11, v11, v10
    buffer_load_dwordx4 v[24:27], v11, s[8:11], 0 offen
    buffer_load_dwordx4 v[28:31], v11, s[8:11], 0 offen offset:16
    buffer_load_dword v32, v11, s[8:11], 0 offen offset:32
    buffer_load_dwordx4 v[34:37], v10, s[28:31], 0 offen
    buffer_load_dwordx4 v[38:41], v10, s[28:31], 0 offen offset:16
    buffer_load_dword v42, v10, s[28:31], 0 offen offset:32
    v_lshlrev_b32 v8, 2, v8
    v_add_u32 v8, 0x800000, v8
    v_cmp_eq_u32 vcc, 0, v9
    v_mov_b32 v10, s75
    s_nop 0
    v_cndmask_b32 v19, v10, v8, vcc
    s_lshl_b32 s79, s2, 2
    s_add_u32 s79, s79, s94
    s_mul_i32 s82, s79, 52429
    s_lshr_b32 s82, s82, 18
    s_mul_i32 s67, s82, 5
    s_sub_u32 s83, s79, s67
    s_cmp_ge_u32 s82, 72
    s_cselect_b64 s[4:5], s[50:51], s[42:43]
    s_cselect_b32 s67, 72, 0
    s_sub_u32 s84, s82, s67
    s_mov_b32 s24, s4
    s_and_b32 s25, s5, 0xffff
    s_mov_b32 s26, 0xa2000
    s_mov_b32 s27, 0x20000
    s_lshr_b32 s85, s84, 1
    s_mul_i32 s85, s85, 18
    s_and_b32 s67, s84, 1
    s_lshl_b32 s67, s67, 3
    s_add_u32 s85, s85, s67
    s_sub_u32 s87, s84, 64
    s_mul_i32 s87, s87, 72
    s_add_u32 s87, s87, 16
    s_cmp_lt_u32 s84, 64
    s_cselect_b32 s85, s85, s87
    s_mul_i32 s85, s85, 1152
    s_lshl_b32 s67, s83, 6
    v_add_u32 v8, s67, v1
    v_lshlrev_b32 v9, 2, v8
    s_mul_i32 s87, s82, 576*16
    s_add_u32 s87, s87, 0x900000
    v_lshl_add_u32 v11, v8, 5, s87
    s_movk_i32 s67, 288
    s_cmp_lt_u32 s79, 720
    s_cselect_b32 s67, s67, 0
    v_cmp_gt_u32 vcc, s67, v8
    v_mov_b32 v10, s75
    s_nop 0
    v_cndmask_b32 v9, v10, v9, vcc
    v_cndmask_b32 v20, v10, v11, vcc
    s_cmp_lt_u32 s84, 64
    s_movk_i32 s67, 0
    s_cselect_b32 s67, s67, 0
    s_add_u32 s67, s67, s85
    buffer_load_dword v54, v9, s[24:27], s67 offen
    s_cmp_lt_u32 s84, 64
    s_movk_i32 s67, 1152
    s_cselect_b32 s67, s67, 1152
    s_add_u32 s67, s67, s85
    buffer_load_dword v55, v9, s[24:27], s67 offen
    s_cmp_lt_u32 s84, 64
    s_movk_i32 s67, 2304
    s_cselect_b32 s67, s67, 20736
    s_add_u32 s67, s67, s85
    buffer_load_dword v56, v9, s[24:27], s67 offen
    s_cmp_lt_u32 s84, 64
    s_movk_i32 s67, 3456
    s_cselect_b32 s67, s67, 21888
    s_add_u32 s67, s67, s85
    buffer_load_dword v57, v9, s[24:27], s67 offen
    s_cmp_lt_u32 s84, 64
    s_movk_i32 s67, 4608
    s_cselect_b32 s67, s67, 41472
    s_add_u32 s67, s67, s85
    buffer_load_dword v58, v9, s[24:27], s67 offen
    s_cmp_lt_u32 s84, 64
    s_movk_i32 s67, 5760
    s_cselect_b32 s67, s67, 42624
    s_add_u32 s67, s67, s85
    buffer_load_dword v59, v9, s[24:27], s67 offen
    s_cmp_lt_u32 s84, 64
    s_movk_i32 s67, 6912
    s_cselect_b32 s67, s67, 62208
    s_add_u32 s67, s67, s85
    buffer_load_dword v60, v9, s[24:27], s67 offen
    s_cmp_lt_u32 s84, 64
    s_movk_i32 s67, 8064
    s_cselect_b32 s67, s67, 63360
    s_add_u32 s67, s67, s85
    buffer_load_dword v61, v9, s[24:27], s67 offen
    s_waitcnt vmcnt(8)
    v_mov_b32 v8, 0
    v_dot2_f32_bf16 v8, v24, v34, v8
    v_dot2_f32_bf16 v8, v25, v35, v8
    v_dot2_f32_bf16 v8, v26, v36, v8
    v_dot2_f32_bf16 v8, v27, v37, v8
    v_dot2_f32_bf16 v8, v28, v38, v8
    v_dot2_f32_bf16 v8, v29, v39, v8
    v_dot2_f32_bf16 v8, v30, v40, v8
    v_dot2_f32_bf16 v8, v31, v41, v8
    v_dot2_f32_bf16 v8, v32, v42, v8
    s_nop 3
    v_add_f32_dpp v8, v8, v8 quad_perm:[1,0,3,2] row_mask:0xf bank_mask:0xf
    s_nop 1
    v_add_f32_dpp v8, v8, v8 quad_perm:[2,3,0,1] row_mask:0xf bank_mask:0xf
    s_nop 1
    v_add_f32_dpp v8, v8, v8 row_half_mirror row_mask:0xf bank_mask:0xf
    s_nop 1
    v_add_f32_dpp v8, v8, v8 row_mirror row_mask:0xf bank_mask:0xf
    ds_swizzle_b32 v9, v8 offset:0x401F
    s_waitcnt lgkmcnt(0)
    v_add_f32 v8, v8, v9
    v_mul_f32 v8, s72, v8
    v_exp_f32 v8, -v8
    s_nop 0
    v_add_f32 v8, 1.0, v8
    v_rcp_f32 v8, v8
    s_nop 0
    buffer_store_dword v8, v19, s[16:19], 0 offen sc1
    s_lshl_b32 s67, s2, 5
    s_add_u32 s67, s67, 0x810000
    v_lshl_add_u32 v8, v1, 2, s67
    s_cmp_eq_u32 s94, 0
    s_cselect_b32 s67, 8, 0
    v_cmp_gt_u32 vcc, s67, v1
    v_mov_b32 v9, s75
    s_nop 0
    v_cndmask_b32 v8, v9, v8, vcc
    v_mov_b32 v12, 0
    buffer_store_dword v12, v8, s[16:19], 0 offen sc1
    s_waitcnt vmcnt(2)
    s_mov_b32 s91, 0x05040100
    s_mov_b32 s85, 0x07060302
    v_perm_b32 v64, v55, v54, s91
    v_perm_b32 v68, v55, v54, s85
    v_perm_b32 v65, v57, v56, s91
    v_perm_b32 v69, v57, v56, s85
    v_perm_b32 v66, v59, v58, s91
    v_perm_b32 v70, v59, v58, s85
    v_perm_b32 v67, v61, v60, s91
    v_perm_b32 v71, v61, v60, s85
    buffer_store_dwordx4 v[64:67], v20, s[16:19], 0 offen sc1
    buffer_store_dwordx4 v[68:71], v20, s[16:19], 0 offen offset:16 sc1
    s_barrier
K1_END:
    s_endpgm
.p2align 8
hh_k23_kernel:
    s_cmp_ge_u32 s2, 256
    s_cbranch_scc1 KF_END
    s_load_dwordx2 s[32:33], s[0:1], 72
    s_load_dwordx2 s[34:35], s[0:1], 88
    s_and_b32 s65, s2, 7
    s_lshr_b32 s66, s2, 3
    v_and_b32 v1, 63, v0
    v_lshrrev_b32 v8, 6, v0
    v_lshrrev_b32 v2, 4, v1
    v_readfirstlane_b32 s64, v8
    v_and_b32 v3, 15, v1
    v_lshrrev_b32 v4, 2, v3
    v_and_b32 v5, 3, v3
    s_and_b32 s94, s64, 3
    s_lshr_b32 s95, s64, 2
    s_mov_b32 s75, 0x40000000
    s_mov_b32 s72, 0x3fb8aa3b
    s_mov_b32 s73, 0x3fb8aa3b
    s_lshl_b32 s82, s65, 2
    s_and_b32 s67, s66, 3
    s_add_u32 s82, s82, s67
    s_lshr_b32 s83, s66, 2
    s_mul_i32 s84, s83, 144
    s_lshl_b32 s60, s65, 3
    s_lshr_b32 s67, s66, 2
    s_add_u32 s60, s60, s67
    s_and_b32 s61, s66, 3
    s_cmp_eq_u32 s95, 2
    s_cbranch_scc1 K23_SRV
    v_mov_b32 v12, 0
    v_mov_b32 v13, 0
    v_mov_b32 v14, 0
    v_mov_b32 v15, 0
    v_min_u32 v8, 239, v0
    v_lshlrev_b32 v8, 4, v8
    v_add_u32 v8, 156672, v8
    ds_write_b128 v8, v[12:15]
    v_mul_u32_u24 v8, 72, v2
    v_and_b32 v9, 1, v2
    v_lshlrev_b32 v9, 3, v9
    v_xor_b32 v9, v9, v3
    v_add_lshl_u32 v16, v8, v9, 4
    v_and_b32 v9, 1, v5
    v_lshl_add_u32 v9, v4, 1, v9
    v_add3_u32 v8, v8, v9, 64
    v_lshlrev_b32 v17, 4, v8
    v_lshlrev_b32 v8, 4, v5
    v_mov_b32 v9, 1920
    v_cmp_eq_u32 vcc, v4, v2
    s_nop 1
    v_cndmask_b32 v8, v9, v8, vcc
    v_add_u32 v20, 156672, v8
    s_lshl_b32 s68, s61, 9
    v_add_u32 v9, s68, v0
    v_lshlrev_b32 v21, 4, v9
    v_lshlrev_b32 v22, 2, v9
    v_lshl_add_u32 v8, v2, 11, v3
    v_lshlrev_b32 v23, 4, v8
    v_lshl_add_u32 v8, v2, 13, v3
    v_lshlrev_b32 v24, 2, v8
    s_lshl_b32 s69, s60, 16
    s_add_u32 s70, s69, 32768
    s_lshl_b32 s71, s60, 13
    s_add_u32 s71, s71, 0x400000
    s_waitcnt lgkmcnt(0)
    s_mov_b32 s16, s34
    s_and_b32 s17, s35, 0xffff
    s_mov_b32 s18, 0x2000000
    s_mov_b32 s19, 0x20000
    s_mov_b32 s8, s32
    s_and_b32 s9, s33, 0xffff
    s_mov_b32 s10, 0x240000
    s_mov_b32 s11, 0x20000
    buffer_load_dwordx4 v[28:31], v21, s[16:19], s69 offen
    buffer_load_dwordx4 v[32:35], v21, s[16:19], s70 offen
    buffer_load_dword v36, v22, s[16:19], s71 offen
    s_lshl_b32 s70, s82, 8
    s_lshl_b32 s67, s94, 6
    s_add_u32 s70, s70, s67
    s_add_u32 s70, s70, 0x800000
    v_lshlrev_b32 v8, 2, v3
    buffer_load_dword v26, v8, s[16:19], s70 offen
    s_barrier
    s_waitcnt vmcnt(1)
    v_lshlrev_b32 v38, 16, v28
    v_and_b32 v39, 0xffff0000, v28
    v_lshlrev_b32 v40, 16, v29
    v_and_b32 v41, 0xffff0000, v29
    v_lshlrev_b32 v42, 16, v30
    v_and_b32 v43, 0xffff0000, v30
    v_lshlrev_b32 v44, 16, v31
    v_and_b32 v45, 0xffff0000, v31
    v_lshlrev_b32 v46, 16, v32
    v_and_b32 v47, 0xffff0000, v32
    v_lshlrev_b32 v48, 16, v33
    v_and_b32 v49, 0xffff0000, v33
    v_lshlrev_b32 v50, 16, v34
    v_and_b32 v51, 0xffff0000, v34
    v_lshlrev_b32 v52, 16, v35
    v_and_b32 v53, 0xffff0000, v35
    v_lshlrev_b32 v54, 16, v36
    v_and_b32 v55, 0xffff0000, v36
    v_max3_f32 v92, v38, v39, v40
    v_min3_f32 v94, v38, v39, v40
    v_max3_f32 v92, v92, v41, v42
    v_min3_f32 v94, v94, v41, v42
    v_max3_f32 v92, v92, v43, v44
    v_min3_f32 v94, v94, v43, v44
    v_max3_f32 v92, v92, v45, v46
    v_min3_f32 v94, v94, v45, v46
    v_max3_f32 v92, v92, v47, v48
    v_min3_f32 v94, v94, v47, v48
    v_max3_f32 v92, v92, v49, v50
    v_min3_f32 v94, v94, v49, v50
    v_max3_f32 v92, v92, v51, v52
    v_min3_f32 v94, v94, v51, v52
    v_max3_f32 v92, v92, v53, v54
    v_min3_f32 v94, v94, v53, v54
    v_max_f32 v92, v92, v55
    v_min_f32 v94, v94, v55
    v_mul_f32 v92, s72, v92
    v_mul_f32 v94, s72, v94
    v_pk_fma_f32 v[56:57], v[38:39], s[72:73], v[92:93] op_sel_hi:[1,1,0] neg_lo:[0,0,1] neg_hi:[0,0,1]
    v_pk_fma_f32 v[74:75], v[38:39], s[72:73], v[94:95] op_sel_hi:[1,1,0] neg_lo:[1,0,0] neg_hi:[1,0,0]
    v_pk_fma_f32 v[58:59], v[40:41], s[72:73], v[92:93] op_sel_hi:[1,1,0] neg_lo:[0,0,1] neg_hi:[0,0,1]
    v_pk_fma_f32 v[76:77], v[40:41], s[72:73], v[94:95] op_sel_hi:[1,1,0] neg_lo:[1,0,0] neg_hi:[1,0,0]
    v_pk_fma_f32 v[60:61], v[42:43], s[72:73], v[92:93] op_sel_hi:[1,1,0] neg_lo:[0,0,1] neg_hi:[0,0,1]
    v_pk_fma_f32 v[78:79], v[42:43], s[72:73], v[94:95] op_sel_hi:[1,1,0] neg_lo:[1,0,0] neg_hi:[1,0,0]
    v_pk_fma_f32 v[62:63], v[44:45], s[72:73], v[92:93] op_sel_hi:[1,1,0] neg_lo:[0,0,1] neg_hi:[0,0,1]
    v_pk_fma_f32 v[80:81], v[44:45], s[72:73], v[94:95] op_sel_hi:[1,1,0] neg_lo:[1,0,0] neg_hi:[1,0,0]
    v_pk_fma_f32 v[64:65], v[46:47], s[72:73], v[92:93] op_sel_hi:[1,1,0] neg_lo:[0,0,1] neg_hi:[0,0,1]
    v_pk_fma_f32 v[82:83], v[46:47], s[72:73], v[94:95] op_sel_hi:[1,1,0] neg_lo:[1,0,0] neg_hi:[1,0,0]
    v_pk_fma_f32 v[66:67], v[48:49], s[72:73], v[92:93] op_sel_hi:[1,1,0] neg_lo:[0,0,1] neg_hi:[0,0,1]
    v_pk_fma_f32 v[84:85], v[48:49], s[72:73], v[94:95] op_sel_hi:[1,1,0] neg_lo:[1,0,0] neg_hi:[1,0,0]
    v_pk_fma_f32 v[68:69], v[50:51], s[72:73], v[92:93] op_sel_hi:[1,1,0] neg_lo:[0,0,1] neg_hi:[0,0,1]
    v_pk_fma_f32 v[86:87], v[50:51], s[72:73], v[94:95] op_sel_hi:[1,1,0] neg_lo:[1,0,0] neg_hi:[1,0,0]
    v_pk_fma_f32 v[70:71], v[52:53], s[72:73], v[92:93] op_sel_hi:[1,1,0] neg_lo:[0,0,1] neg_hi:[0,0,1]
    v_pk_fma_f32 v[88:89], v[52:53], s[72:73], v[94:95] op_sel_hi:[1,1,0] neg_lo:[1,0,0] neg_hi:[1,0,0]
    v_pk_fma_f32 v[72:73], v[54:55], s[72:73], v[92:93] op_sel_hi:[1,1,0] neg_lo:[0,0,1] neg_hi:[0,0,1]
    v_pk_fma_f32 v[90:91], v[54:55], s[72:73], v[94:95] op_sel_hi:[1,1,0] neg_lo:[1,0,0] neg_hi:[1,0,0]
    v_exp_f32 v56, v56
    v_exp_f32 v74, v74
    v_exp_f32 v57, v57
    v_exp_f32 v75, v75
    v_exp_f32 v58, v58
    v_exp_f32 v76, v76
    v_exp_f32 v59, v59
    v_exp_f32 v77, v77
    v_exp_f32 v60, v60
    v_exp_f32 v78, v78
    v_exp_f32 v61, v61
    v_exp_f32 v79, v79
    v_exp_f32 v62, v62
    v_exp_f32 v80, v80
    v_exp_f32 v63, v63
    v_exp_f32 v81, v81
    v_exp_f32 v64, v64
    v_exp_f32 v82, v82
    v_exp_f32 v65, v65
    v_exp_f32 v83, v83
    v_exp_f32 v66, v66
    v_exp_f32 v84, v84
    v_exp_f32 v67, v67
    v_exp_f32 v85, v85
    v_exp_f32 v68, v68
    v_exp_f32 v86, v86
    v_exp_f32 v69, v69
    v_exp_f32 v87, v87
    v_exp_f32 v70, v70
    v_exp_f32 v88, v88
    v_exp_f32 v71, v71
    v_exp_f32 v89, v89
    v_exp_f32 v72, v72
    v_exp_f32 v90, v90
    v_exp_f32 v73, v73
    v_exp_f32 v91, v91
    v_cvt_pk_bf16_f32 v96, v56, v57
    v_cvt_pk_bf16_f32 v105, v74, v75
    v_cvt_pk_bf16_f32 v97, v58, v59
    v_cvt_pk_bf16_f32 v106, v76, v77
    v_cvt_pk_bf16_f32 v98, v60, v61
    v_cvt_pk_bf16_f32 v107, v78, v79
    v_cvt_pk_bf16_f32 v99, v62, v63
    v_cvt_pk_bf16_f32 v108, v80, v81
    v_cvt_pk_bf16_f32 v100, v64, v65
    v_cvt_pk_bf16_f32 v109, v82, v83
    v_cvt_pk_bf16_f32 v101, v66, v67
    v_cvt_pk_bf16_f32 v110, v84, v85
    v_cvt_pk_bf16_f32 v102, v68, v69
    v_cvt_pk_bf16_f32 v111, v86, v87
    v_cvt_pk_bf16_f32 v103, v70, v71
    v_cvt_pk_bf16_f32 v112, v88, v89
    v_cvt_pk_bf16_f32 v104, v72, v73
    v_cvt_pk_bf16_f32 v113, v90, v91
    v_mov_b32 v114, 0
    v_mov_b32 v115, 0
    s_lshr_b32 s62, s60, 5
    s_and_b32 s63, s60, 31
    s_mul_i32 s67, s62, 72
    s_lshl_b32 s69, s63, 1
    s_add_u32 s69, s69, s67
    s_lshl_b32 s69, s69, 15
    s_add_u32 s69, s69, 0xb00000
    s_add_u32 s70, s69, 32768
    s_lshl_b32 s71, s60, 13
    s_add_u32 s71, s71, 0xa80000
    s_barrier
    ds_read_b128 v[68:71], v20 offset:0
    ds_read_b128 v[72:75], v20 offset:64
    ds_read_b128 v[76:79], v20 offset:128
    ds_read_b128 v[80:83], v20 offset:192
    ds_read_b128 v[84:87], v20 offset:256
    ds_read_b128 v[88:91], v20 offset:320
    ds_read_b128 v[116:119], v20 offset:384
    ds_read_b128 v[120:123], v20 offset:448
    ds_read_b128 v[124:127], v20 offset:512
    s_waitcnt lgkmcnt(6)
    v_mfma_f32_16x16x32_bf16 v[28:31], v[68:71], v[96:99], 0
    v_mfma_f32_16x16x32_bf16 v[28:31], v[72:75], v[100:103], v[28:31]
    v_mfma_f32_16x16x32_bf16 v[28:31], v[76:79], v[104:107], v[28:31]
    ds_read_b128 v[68:71], v20 offset:576
    ds_read_b128 v[72:75], v20 offset:640
    ds_read_b128 v[76:79], v20 offset:704
    s_waitcnt lgkmcnt(6)
    v_mfma_f32_16x16x32_bf16 v[32:35], v[80:83], v[96:99], 0
    v_mfma_f32_16x16x32_bf16 v[32:35], v[84:87], v[100:103], v[32:35]
    v_mfma_f32_16x16x32_bf16 v[32:35], v[88:91], v[104:107], v[32:35]
    ds_read_b128 v[80:83], v20 offset:768
    ds_read_b128 v[84:87], v20 offset:832
    ds_read_b128 v[88:91], v20 offset:896
    s_waitcnt lgkmcnt(6)
    v_mfma_f32_16x16x32_bf16 v[36:39], v[116:119], v[96:99], 0
    v_mfma_f32_16x16x32_bf16 v[36:39], v[120:123], v[100:103], v[36:39]
    v_mfma_f32_16x16x32_bf16 v[36:39], v[124:127], v[104:107], v[36:39]
    ds_read_b128 v[116:119], v20 offset:960
    ds_read_b128 v[120:123], v20 offset:1024
    ds_read_b128 v[124:127], v20 offset:1088
    s_waitcnt lgkmcnt(6)
    v_mfma_f32_16x16x32_bf16 v[40:43], v[68:71], v[96:99], 0
    v_mfma_f32_16x16x32_bf16 v[40:43], v[72:75], v[100:103], v[40:43]
    v_mfma_f32_16x16x32_bf16 v[40:43], v[76:79], v[104:107], v[40:43]
    ds_read_b128 v[68:71], v20 offset:1152
    ds_read_b128 v[72:75], v20 offset:1216
    ds_read_b128 v[76:79], v20 offset:1280
    s_waitcnt lgkmcnt(6)
    v_mfma_f32_16x16x32_bf16 v[44:47], v[80:83], v[96:99], 0
    v_mfma_f32_16x16x32_bf16 v[44:47], v[84:87], v[100:103], v[44:47]
    v_mfma_f32_16x16x32_bf16 v[44:47], v[88:91], v[104:107], v[44:47]
    ds_read_b128 v[80:83], v20 offset:1344
    ds_read_b128 v[84:87], v20 offset:1408
    ds_read_b128 v[88:91], v20 offset:1472
    s_waitcnt lgkmcnt(6)
    v_mfma_f32_16x16x32_bf16 v[48:51], v[116:119], v[104:107], 0
    v_mfma_f32_16x16x32_bf16 v[48:51], v[120:123], v[108:111], v[48:51]
    v_mfma_f32_16x16x32_bf16 v[48:51], v[124:127], v[112:115], v[48:51]
    ds_read_b128 v[116:119], v20 offset:1536
    ds_read_b128 v[120:123], v20 offset:1600
    ds_read_b128 v[124:127], v20 offset:1664
    s_waitcnt lgkmcnt(6)
    v_mfma_f32_16x16x32_bf16 v[52:55], v[68:71], v[104:107], 0
    v_mfma_f32_16x16x32_bf16 v[52:55], v[72:75], v[108:111], v[52:55]
    v_mfma_f32_16x16x32_bf16 v[52:55], v[76:79], v[112:115], v[52:55]
    ds_read_b128 v[68:71], v20 offset:1728
    ds_read_b128 v[72:75], v20 offset:1792
    ds_read_b128 v[76:79], v20 offset:1856
    s_waitcnt lgkmcnt(6)
    v_mfma_f32_16x16x32_bf16 v[56:59], v[80:83], v[104:107], 0
    v_mfma_f32_16x16x32_bf16 v[56:59], v[84:87], v[108:111], v[56:59]
    v_mfma_f32_16x16x32_bf16 v[56:59], v[88:91], v[112:115], v[56:59]
    s_waitcnt lgkmcnt(3)
    v_mfma_f32_16x16x32_bf16 v[60:63], v[116:119], v[104:107], 0
    v_mfma_f32_16x16x32_bf16 v[60:63], v[120:123], v[108:111], v[60:63]
    v_mfma_f32_16x16x32_bf16 v[60:63], v[124:127], v[112:115], v[60:63]
    s_waitcnt lgkmcnt(0)
    v_mfma_f32_16x16x32_bf16 v[64:67], v[68:71], v[104:107], 0
    v_mfma_f32_16x16x32_bf16 v[64:67], v[72:75], v[108:111], v[64:67]
    v_mfma_f32_16x16x32_bf16 v[64:67], v[76:79], v[112:115], v[64:67]
    v_rcp_f32 v10, v47
    s_nop 6
    v_rcp_f32 v12, v67
    v_mov_b32 v14, 0x358637bd
    v_fmac_f32 v14, v46, v10
    v_fmac_f32 v14, v66, v12
    v_rcp_f32 v14, v14
    s_nop 0
    v_mul_f32 v10, v10, v14
    v_mul_f32 v12, v12, v14
    v_pk_mul_f32 v[28:29], v[28:29], v[10:11] op_sel_hi:[1,0]
    v_pk_fma_f32 v[28:29], v[48:49], v[12:13], v[28:29] op_sel_hi:[1,0,1]
    v_pk_mul_f32 v[30:31], v[30:31], v[10:11] op_sel_hi:[1,0]
    v_pk_fma_f32 v[30:31], v[50:51], v[12:13], v[30:31] op_sel_hi:[1,0,1]
    v_pk_mul_f32 v[32:33], v[32:33], v[10:11] op_sel_hi:[1,0]
    v_pk_fma_f32 v[32:33], v[52:53], v[12:13], v[32:33] op_sel_hi:[1,0,1]
    v_pk_mul_f32 v[34:35], v[34:35], v[10:11] op_sel_hi:[1,0]
    v_pk_fma_f32 v[34:35], v[54:55], v[12:13], v[34:35] op_sel_hi:[1,0,1]
    v_pk_mul_f32 v[36:37], v[36:37], v[10:11] op_sel_hi:[1,0]
    v_pk_fma_f32 v[36:37], v[56:57], v[12:13], v[36:37] op_sel_hi:[1,0,1]
    v_pk_mul_f32 v[38:39], v[38:39], v[10:11] op_sel_hi:[1,0]
    v_pk_fma_f32 v[38:39], v[58:59], v[12:13], v[38:39] op_sel_hi:[1,0,1]
    v_pk_mul_f32 v[40:41], v[40:41], v[10:11] op_sel_hi:[1,0]
    v_pk_fma_f32 v[40:41], v[60:61], v[12:13], v[40:41] op_sel_hi:[1,0,1]
    v_pk_mul_f32 v[42:43], v[42:43], v[10:11] op_sel_hi:[1,0]
    v_pk_fma_f32 v[42:43], v[62:63], v[12:13], v[42:43] op_sel_hi:[1,0,1]
    v_pk_mul_f32 v[44:45], v[44:45], v[10:11] op_sel_hi:[1,0]
    v_pk_fma_f32 v[44:45], v[64:65], v[12:13], v[44:45] op_sel_hi:[1,0,1]
    v_cvt_pk_bf16_f32 v96, v28, v29
    v_cvt_pk_bf16_f32 v97, v30, v31
    v_cvt_pk_bf16_f32 v98, v32, v33
    v_cvt_pk_bf16_f32 v99, v34, v35
    v_cvt_pk_bf16_f32 v100, v36, v37
    v_cvt_pk_bf16_f32 v101, v38, v39
    v_cvt_pk_bf16_f32 v102, v40, v41
    v_cvt_pk_bf16_f32 v103, v42, v43
    v_cvt_pk_bf16_f32 v104, v44, v45
    buffer_store_dwordx4 v[96:99], v21, s[16:19], s69 offen sc1
    buffer_store_dwordx4 v[100:103], v21, s[16:19], s70 offen sc1
    buffer_store_dword v104, v22, s[16:19], s71 offen sc1
    s_cmp_eq_u32 s95, 0
    s_mov_b32 s67, 147456
    s_cselect_b32 s67, s67, 138240
    v_add_u32 v10, s67, v16
    v_add_u32 v11, s67, v17
    ds_read_b128 v[128:131], v10 offset:0
    ds_read_b128 v[132:135], v10 offset:256
    ds_read_b128 v[136:139], v10 offset:512
    ds_read_b128 v[140:143], v10 offset:768
    ds_read_b128 v[144:147], v11 offset:0
    ds_read_b128 v[148:151], v10 offset:4608
    ds_read_b128 v[152:155], v10 offset:4864
    ds_read_b128 v[156:159], v10 offset:5120
    ds_read_b128 v[160:163], v10 offset:5376
    ds_read_b128 v[164:167], v11 offset:4608
    s_mul_i32 s67, s95, 8*9216
    v_add_u32 v16, s67, v16
    v_add_u32 v17, s67, v17
    v_add_u32 v18, 36864, v16
    v_add_u32 v19, 36864, v17
    s_mul_i32 s68, s95, 72*2048*16
    s_lshl_b32 s67, s82, 10
    s_add_u32 s68, s68, s67
    s_lshl_b32 s67, s94, 8
    s_add_u32 s68, s68, s67
    s_add_u32 s68, s68, 0xb00000
    s_lshl_b32 s69, s95, 18
    s_lshl_b32 s67, s82, 8
    s_add_u32 s69, s69, s67
    s_lshl_b32 s67, s94, 6
    s_add_u32 s69, s69, s67
    s_add_u32 s69, s69, 0xa80000
    s_lshl_b32 s67, s61, 3
    s_add_u32 s67, s67, s64
    s_lshl_b32 s67, s67, 6
    s_add_u32 s67, s67, s60
    s_lshl_b32 s67, s67, 2
    s_add_u32 s67, s67, 0x810000
    v_mov_b32 v8, s67
    v_mov_b32 v9, 1
    s_waitcnt vmcnt(0) lgkmcnt(0)
    s_mov_b64 exec, 1
    buffer_store_dword v9, v8, s[16:19], 0 offen sc1
    s_mov_b64 exec, -1
    s_barrier
    s_barrier
    s_add_u32 s67, s69, 0
    buffer_load_dword v60, v24, s[16:19], s67 offen sc1
    s_add_u32 s67, s69, 8192
    buffer_load_dword v61, v24, s[16:19], s67 offen sc1
    s_add_u32 s67, s69, 16384
    buffer_load_dword v62, v24, s[16:19], s67 offen sc1
    s_add_u32 s67, s69, 24576
    buffer_load_dword v63, v24, s[16:19], s67 offen sc1
    s_add_u32 s67, s69, 131072
    buffer_load_dword v64, v24, s[16:19], s67 offen sc1
    s_add_u32 s67, s69, 139264
    buffer_load_dword v65, v24, s[16:19], s67 offen sc1
    s_add_u32 s67, s69, 147456
    buffer_load_dword v66, v24, s[16:19], s67 offen sc1
    s_add_u32 s67, s69, 155648
    buffer_load_dword v67, v24, s[16:19], s67 offen sc1
    s_add_u32 s67, s68, 0
    buffer_load_dwordx4 v[28:31], v23, s[16:19], s67 offen sc1
    s_add_u32 s67, s68, 131072
    buffer_load_dwordx4 v[32:35], v23, s[16:19], s67 offen sc1
    s_add_u32 s67, s68, 262144
    buffer_load_dwordx4 v[36:39], v23, s[16:19], s67 offen sc1
    s_add_u32 s67, s68, 393216
    buffer_load_dwordx4 v[40:43], v23, s[16:19], s67 offen sc1
    s_add_u32 s67, s68, 524288
    buffer_load_dwordx4 v[44:47], v23, s[16:19], s67 offen sc1
    s_add_u32 s67, s68, 655360
    buffer_load_dwordx4 v[48:51], v23, s[16:19], s67 offen sc1
    ds_read_b128 v[88:91], v16 offset:0
    ds_read_b128 v[92:95], v16 offset:256
    ds_read_b128 v[96:99], v16 offset:512
    ds_read_b128 v[100:103], v16 offset:768
    s_waitcnt vmcnt(10)
    v_mfma_f32_16x16x32_bf16 v[68:71], v[128:131], v[60:63], 0
    v_mfma_f32_16x16x32_bf16 v[72:75], v[132:135], v[60:63], 0
    v_mfma_f32_16x16x32_bf16 v[76:79], v[136:139], v[60:63], 0
    v_mfma_f32_16x16x32_bf16 v[80:83], v[140:143], v[60:63], 0
    v_mfma_f32_16x16x32_bf16 v[84:87], v[144:147], v[60:63], 0
    s_waitcnt vmcnt(6)
    v_mfma_f32_16x16x32_bf16 v[68:71], v[148:151], v[64:67], v[68:71]
    v_mfma_f32_16x16x32_bf16 v[72:75], v[152:155], v[64:67], v[72:75]
    v_mfma_f32_16x16x32_bf16 v[76:79], v[156:159], v[64:67], v[76:79]
    v_mfma_f32_16x16x32_bf16 v[80:83], v[160:163], v[64:67], v[80:83]
    v_mfma_f32_16x16x32_bf16 v[84:87], v[164:167], v[64:67], v[84:87]
    s_waitcnt vmcnt(5)
    s_waitcnt lgkmcnt(3)
    v_mfma_f32_16x16x32_bf16 v[68:71], v[88:91], v[28:31], v[68:71]
    ds_read_b128 v[104:107], v17 offset:0
    s_add_u32 s67, s68, 786432
    buffer_load_dwordx4 v[52:55], v23, s[16:19], s67 offen sc1
    s_waitcnt lgkmcnt(3)
    v_mfma_f32_16x16x32_bf16 v[72:75], v[92:95], v[28:31], v[72:75]
    ds_read_b128 v[88:91], v16 offset:4608
    s_waitcnt lgkmcnt(3)
    v_mfma_f32_16x16x32_bf16 v[76:79], v[96:99], v[28:31], v[76:79]
    ds_read_b128 v[92:95], v16 offset:4864
    s_waitcnt lgkmcnt(3)
    v_mfma_f32_16x16x32_bf16 v[80:83], v[100:103], v[28:31], v[80:83]
    ds_read_b128 v[96:99], v16 offset:5120
    s_waitcnt lgkmcnt(3)
    v_mfma_f32_16x16x32_bf16 v[84:87], v[104:107], v[28:31], v[84:87]
    ds_read_b128 v[100:103], v16 offset:5376
    s_waitcnt vmcnt(5)
    s_waitcnt lgkmcnt(3)
    v_mfma_f32_16x16x32_bf16 v[68:71], v[88:91], v[32:35], v[68:71]
    ds_read_b128 v[104:107], v17 offset:4608
    s_add_u32 s67, s68, 917504
    buffer_load_dwordx4 v[56:59], v23, s[16:19], s67 offen sc1
    s_waitcnt lgkmcnt(3)
    v_mfma_f32_16x16x32_bf16 v[72:75], v[92:95], v[32:35], v[72:75]
    ds_read_b128 v[88:91], v16 offset:9216
    s_waitcnt lgkmcnt(3)
    v_mfma_f32_16x16x32_bf16 v[76:79], v[96:99], v[32:35], v[76:79]
    ds_read_b128 v[92:95], v16 offset:9472
    s_waitcnt lgkmcnt(3)
    v_mfma_f32_16x16x32_bf16 v[80:83], v[100:103], v[32:35], v[80:83]
    ds_read_b128 v[96:99], v16 offset:9728
    s_waitcnt lgkmcnt(3)
    v_mfma_f32_16x16x32_bf16 v[84:87], v[104:107], v[32:35], v[84:87]
    ds_read_b128 v[100:103], v16 offset:9984
    s_waitcnt vmcnt(5)
    s_waitcnt lgkmcnt(3)
    v_mfma_f32_16x16x32_bf16 v[68:71], v[88:91], v[36:39], v[68:71]
    ds_read_b128 v[104:107], v17 offset:9216
    s_add_u32 s67, s68, 1048576
    buffer_load_dwordx4 v[28:31], v23, s[16:19], s67 offen sc1
    s_waitcnt lgkmcnt(3)
    v_mfma_f32_16x16x32_bf16 v[72:75], v[92:95], v[36:39], v[72:75]
    ds_read_b128 v[88:91], v16 offset:13824
    s_waitcnt lgkmcnt(3)
    v_mfma_f32_16x16x32_bf16 v[76:79], v[96:99], v[36:39], v[76:79]
    ds_read_b128 v[92:95], v16 offset:14080
    s_waitcnt lgkmcnt(3)
    v_mfma_f32_16x16x32_bf16 v[80:83], v[100:103], v[36:39], v[80:83]
    ds_read_b128 v[96:99], v16 offset:14336
    s_waitcnt lgkmcnt(3)
    v_mfma_f32_16x16x32_bf16 v[84:87], v[104:107], v[36:39], v[84:87]
    ds_read_b128 v[100:103], v16 offset:14592
    s_waitcnt vmcnt(5)
    s_waitcnt lgkmcnt(3)
    v_mfma_f32_16x16x32_bf16 v[68:71], v[88:91], v[40:43], v[68:71]
    ds_read_b128 v[104:107], v17 offset:13824
    s_add_u32 s67, s68, 1179648
    buffer_load_dwordx4 v[32:35], v23, s[16:19], s67 offen sc1
    s_waitcnt lgkmcnt(3)
    v_mfma_f32_16x16x32_bf16 v[72:75], v[92:95], v[40:43], v[72:75]
    ds_read_b128 v[88:91], v16 offset:18432
    s_waitcnt lgkmcnt(3)
    v_mfma_f32_16x16x32_bf16 v[76:79], v[96:99], v[40:43], v[76:79]
    ds_read_b128 v[92:95], v16 offset:18688
    s_waitcnt lgkmcnt(3)
    v_mfma_f32_16x16x32_bf16 v[80:83], v[100:103], v[40:43], v[80:83]
    ds_read_b128 v[96:99], v16 offset:18944
    s_waitcnt lgkmcnt(3)
    v_mfma_f32_16x16x32_bf16 v[84:87], v[104:107], v[40:43], v[84:87]
    ds_read_b128 v[100:103], v16 offset:19200
    s_waitcnt vmcnt(5)
    s_waitcnt lgkmcnt(3)
    v_mfma_f32_16x16x32_bf16 v[68:71], v[88:91], v[44:47], v[68:71]
    ds_read_b128 v[104:107], v17 offset:18432
    s_add_u32 s67, s68, 1310720
    buffer_load_dwordx4 v[36:39], v23, s[16:19], s67 offen sc1
    s_waitcnt lgkmcnt(3)
    v_mfma_f32_16x16x32_bf16 v[72:75], v[92:95], v[44:47], v[72:75]
    ds_read_b128 v[88:91], v16 offset:23040
    s_waitcnt lgkmcnt(3)
    v_mfma_f32_16x16x32_bf16 v[76:79], v[96:99], v[44:47], v[76:79]
    ds_read_b128 v[92:95], v16 offset:23296
    s_waitcnt lgkmcnt(3)
    v_mfma_f32_16x16x32_bf16 v[80:83], v[100:103], v[44:47], v[80:83]
    ds_read_b128 v[96:99], v16 offset:23552
    s_waitcnt lgkmcnt(3)
    v_mfma_f32_16x16x32_bf16 v[84:87], v[104:107], v[44:47], v[84:87]
    ds_read_b128 v[100:103], v16 offset:23808
    s_waitcnt vmcnt(5)
    s_waitcnt lgkmcnt(3)
    v_mfma_f32_16x16x32_bf16 v[68:71], v[88:91], v[48:51], v[68:71]
    ds_read_b128 v[104:107], v17 offset:23040
    s_add_u32 s67, s68, 1441792
    buffer_load_dwordx4 v[40:43], v23, s[16:19], s67 offen sc1
    s_waitcnt lgkmcnt(3)
    v_mfma_f32_16x16x32_bf16 v[72:75], v[92:95], v[48:51], v[72:75]
    ds_read_b128 v[88:91], v16 offset:27648
    s_waitcnt lgkmcnt(3)
    v_mfma_f32_16x16x32_bf16 v[76:79], v[96:99], v[48:51], v[76:79]
    ds_read_b128 v[92:95], v16 offset:27904
    s_waitcnt lgkmcnt(3)
    v_mfma_f32_16x16x32_bf16 v[80:83], v[100:103], v[48:51], v[80:83]
    ds_read_b128 v[96:99], v16 offset:28160
    s_waitcnt lgkmcnt(3)
    v_mfma_f32_16x16x32_bf16 v[84:87], v[104:107], v[48:51], v[84:87]
    ds_read_b128 v[100:103], v16 offset:28416
    s_waitcnt vmcnt(5)
    s_waitcnt lgkmcnt(3)
    v_mfma_f32_16x16x32_bf16 v[68:71], v[88:91], v[52:55], v[68:71]
    ds_read_b128 v[104:107], v17 offset:27648
    s_add_u32 s67, s68, 1572864
    buffer_load_dwordx4 v[44:47], v23, s[16:19], s67 offen sc1
    s_waitcnt lgkmcnt(3)
    v_mfma_f32_16x16x32_bf16 v[72:75], v[92:95], v[52:55], v[72:75]
    ds_read_b128 v[88:91], v16 offset:32256
    s_waitcnt lgkmcnt(3)
    v_mfma_f32_16x16x32_bf16 v[76:79], v[96:99], v[52:55], v[76:79]
    ds_read_b128 v[92:95], v16 offset:32512
    s_waitcnt lgkmcnt(3)
    v_mfma_f32_16x16x32_bf16 v[80:83], v[100:103], v[52:55], v[80:83]
    ds_read_b128 v[96:99], v16 offset:32768
    s_waitcnt lgkmcnt(3)
    v_mfma_f32_16x16x32_bf16 v[84:87], v[104:107], v[52:55], v[84:87]
    ds_read_b128 v[100:103], v16 offset:33024
    s_waitcnt vmcnt(5)
    s_waitcnt lgkmcnt(3)
    v_mfma_f32_16x16x32_bf16 v[68:71], v[88:91], v[56:59], v[68:71]
    ds_read_b128 v[104:107], v17 offset:32256
    s_add_u32 s67, s68, 1703936
    buffer_load_dwordx4 v[48:51], v23, s[16:19], s67 offen sc1
    s_waitcnt lgkmcnt(3)
    v_mfma_f32_16x16x32_bf16 v[72:75], v[92:95], v[56:59], v[72:75]
    ds_read_b128 v[88:91], v18 offset:0
    s_waitcnt lgkmcnt(3)
    v_mfma_f32_16x16x32_bf16 v[76:79], v[96:99], v[56:59], v[76:79]
    ds_read_b128 v[92:95], v18 offset:256
    s_waitcnt lgkmcnt(3)
    v_mfma_f32_16x16x32_bf16 v[80:83], v[100:103], v[56:59], v[80:83]
    ds_read_b128 v[96:99], v18 offset:512
    s_waitcnt lgkmcnt(3)
    v_mfma_f32_16x16x32_bf16 v[84:87], v[104:107], v[56:59], v[84:87]
    ds_read_b128 v[100:103], v18 offset:768
    s_waitcnt vmcnt(5)
    s_waitcnt lgkmcnt(3)
    v_mfma_f32_16x16x32_bf16 v[68:71], v[88:91], v[28:31], v[68:71]
    ds_read_b128 v[104:107], v19 offset:0
    s_add_u32 s67, s68, 1835008
    buffer_load_dwordx4 v[52:55], v23, s[16:19], s67 offen sc1
    s_waitcnt lgkmcnt(3)
    v_mfma_f32_16x16x32_bf16 v[72:75], v[92:95], v[28:31], v[72:75]
    ds_read_b128 v[88:91], v18 offset:4608
    s_waitcnt lgkmcnt(3)
    v_mfma_f32_16x16x32_bf16 v[76:79], v[96:99], v[28:31], v[76:79]
    ds_read_b128 v[92:95], v18 offset:4864
    s_waitcnt lgkmcnt(3)
    v_mfma_f32_16x16x32_bf16 v[80:83], v[100:103], v[28:31], v[80:83]
    ds_read_b128 v[96:99], v18 offset:5120
    s_waitcnt lgkmcnt(3)
    v_mfma_f32_16x16x32_bf16 v[84:87], v[104:107], v[28:31], v[84:87]
    ds_read_b128 v[100:103], v18 offset:5376
    s_waitcnt vmcnt(5)
    s_waitcnt lgkmcnt(3)
    v_mfma_f32_16x16x32_bf16 v[68:71], v[88:91], v[32:35], v[68:71]
    ds_read_b128 v[104:107], v19 offset:4608
    s_add_u32 s67, s68, 1966080
    buffer_load_dwordx4 v[56:59], v23, s[16:19], s67 offen sc1
    s_waitcnt lgkmcnt(3)
    v_mfma_f32_16x16x32_bf16 v[72:75], v[92:95], v[32:35], v[72:75]
    ds_read_b128 v[88:91], v18 offset:9216
    s_waitcnt lgkmcnt(3)
    v_mfma_f32_16x16x32_bf16 v[76:79], v[96:99], v[32:35], v[76:79]
    ds_read_b128 v[92:95], v18 offset:9472
    s_waitcnt lgkmcnt(3)
    v_mfma_f32_16x16x32_bf16 v[80:83], v[100:103], v[32:35], v[80:83]
    ds_read_b128 v[96:99], v18 offset:9728
    s_waitcnt lgkmcnt(3)
    v_mfma_f32_16x16x32_bf16 v[84:87], v[104:107], v[32:35], v[84:87]
    ds_read_b128 v[100:103], v18 offset:9984
    s_waitcnt vmcnt(5)
    s_waitcnt lgkmcnt(3)
    v_mfma_f32_16x16x32_bf16 v[68:71], v[88:91], v[36:39], v[68:71]
    ds_read_b128 v[104:107], v19 offset:9216
    s_waitcnt lgkmcnt(3)
    v_mfma_f32_16x16x32_bf16 v[72:75], v[92:95], v[36:39], v[72:75]
    ds_read_b128 v[88:91], v18 offset:13824
    s_waitcnt lgkmcnt(3)
    v_mfma_f32_16x16x32_bf16 v[76:79], v[96:99], v[36:39], v[76:79]
    ds_read_b128 v[92:95], v18 offset:14080
    s_waitcnt lgkmcnt(3)
    v_mfma_f32_16x16x32_bf16 v[80:83], v[100:103], v[36:39], v[80:83]
    ds_read_b128 v[96:99], v18 offset:14336
    s_waitcnt lgkmcnt(3)
    v_mfma_f32_16x16x32_bf16 v[84:87], v[104:107], v[36:39], v[84:87]
    ds_read_b128 v[100:103], v18 offset:14592
    s_waitcnt vmcnt(4)
    s_waitcnt lgkmcnt(3)
    v_mfma_f32_16x16x32_bf16 v[68:71], v[88:91], v[40:43], v[68:71]
    ds_read_b128 v[104:107], v19 offset:13824
    s_waitcnt lgkmcnt(3)
    v_mfma_f32_16x16x32_bf16 v[72:75], v[92:95], v[40:43], v[72:75]
    ds_read_b128 v[88:91], v18 offset:18432
    s_waitcnt lgkmcnt(3)
    v_mfma_f32_16x16x32_bf16 v[76:79], v[96:99], v[40:43], v[76:79]
    ds_read_b128 v[92:95], v18 offset:18688
    s_waitcnt lgkmcnt(3)
    v_mfma_f32_16x16x32_bf16 v[80:83], v[100:103], v[40:43], v[80:83]
    ds_read_b128 v[96:99], v18 offset:18944
    s_waitcnt lgkmcnt(3)
    v_mfma_f32_16x16x32_bf16 v[84:87], v[104:107], v[40:43], v[84:87]
    ds_read_b128 v[100:103], v18 offset:19200
    s_waitcnt vmcnt(3)
    s_waitcnt lgkmcnt(3)
    v_mfma_f32_16x16x32_bf16 v[68:71], v[88:91], v[44:47], v[68:71]
    ds_read_b128 v[104:107], v19 offset:18432
    s_waitcnt lgkmcnt(3)
    v_mfma_f32_16x16x32_bf16 v[72:75], v[92:95], v[44:47], v[72:75]
    ds_read_b128 v[88:91], v18 offset:23040
    s_waitcnt lgkmcnt(3)
    v_mfma_f32_16x16x32_bf16 v[76:79], v[96:99], v[44:47], v[76:79]
    ds_read_b128 v[92:95], v18 offset:23296
    s_waitcnt lgkmcnt(3)
    v_mfma_f32_16x16x32_bf16 v[80:83], v[100:103], v[44:47], v[80:83]
    ds_read_b128 v[96:99], v18 offset:23552
    s_waitcnt lgkmcnt(3)
    v_mfma_f32_16x16x32_bf16 v[84:87], v[104:107], v[44:47], v[84:87]
    ds_read_b128 v[100:103], v18 offset:23808
    s_waitcnt vmcnt(2)
    s_waitcnt lgkmcnt(3)
    v_mfma_f32_16x16x32_bf16 v[68:71], v[88:91], v[48:51], v[68:71]
    ds_read_b128 v[104:107], v19 offset:23040
    s_waitcnt lgkmcnt(3)
    v_mfma_f32_16x16x32_bf16 v[72:75], v[92:95], v[48:51], v[72:75]
    ds_read_b128 v[88:91], v18 offset:27648
    s_waitcnt lgkmcnt(3)
    v_mfma_f32_16x16x32_bf16 v[76:79], v[96:99], v[48:51], v[76:79]
    ds_read_b128 v[92:95], v18 offset:27904
    s_waitcnt lgkmcnt(3)
    v_mfma_f32_16x16x32_bf16 v[80:83], v[100:103], v[48:51], v[80:83]
    ds_read_b128 v[96:99], v18 offset:28160
    s_waitcnt lgkmcnt(3)
    v_mfma_f32_16x16x32_bf16 v[84:87], v[104:107], v[48:51], v[84:87]
    ds_read_b128 v[100:103], v18 offset:28416
    s_waitcnt vmcnt(1)
    s_waitcnt lgkmcnt(3)
    v_mfma_f32_16x16x32_bf16 v[68:71], v[88:91], v[52:55], v[68:71]
    ds_read_b128 v[104:107], v19 offset:27648
    s_waitcnt lgkmcnt(3)
    v_mfma_f32_16x16x32_bf16 v[72:75], v[92:95], v[52:55], v[72:75]
    ds_read_b128 v[88:91], v18 offset:32256
    s_waitcnt lgkmcnt(3)
    v_mfma_f32_16x16x32_bf16 v[76:79], v[96:99], v[52:55], v[76:79]
    ds_read_b128 v[92:95], v18 offset:32512
    s_waitcnt lgkmcnt(3)
    v_mfma_f32_16x16x32_bf16 v[80:83], v[100:103], v[52:55], v[80:83]
    ds_read_b128 v[96:99], v18 offset:32768
    s_waitcnt lgkmcnt(3)
    v_mfma_f32_16x16x32_bf16 v[84:87], v[104:107], v[52:55], v[84:87]
    ds_read_b128 v[100:103], v18 offset:33024
    s_waitcnt vmcnt(0)
    s_waitcnt lgkmcnt(3)
    v_mfma_f32_16x16x32_bf16 v[68:71], v[88:91], v[56:59], v[68:71]
    ds_read_b128 v[104:107], v19 offset:32256
    s_waitcnt lgkmcnt(3)
    v_mfma_f32_16x16x32_bf16 v[72:75], v[92:95], v[56:59], v[72:75]
    s_waitcnt lgkmcnt(2)
    v_mfma_f32_16x16x32_bf16 v[76:79], v[96:99], v[56:59], v[76:79]
    s_waitcnt lgkmcnt(1)
    v_mfma_f32_16x16x32_bf16 v[80:83], v[100:103], v[56:59], v[80:83]
    s_waitcnt lgkmcnt(0)
    v_mfma_f32_16x16x32_bf16 v[84:87], v[104:107], v[56:59], v[84:87]
    s_barrier
    s_mul_i32 s67, s94, 5120
    v_lshl_add_u32 v8, v1, 4, s67
    s_cmp_eq_u32 s95, 0
    s_cbranch_scc1 P3_RECV
    ds_write_b128 v8, v[68:71] offset:0
    ds_write_b128 v8, v[72:75] offset:1024
    ds_write_b128 v8, v[76:79] offset:2048
    ds_write_b128 v8, v[80:83] offset:3072
    ds_write_b128 v8, v[84:87] offset:4096
    s_waitcnt lgkmcnt(0)
    s_barrier
    s_branch P3_FIN
P3_RECV:
    s_lshl_b32 s67, s82, 6
    s_lshl_b32 s71, s94, 4
    s_add_u32 s67, s67, s71
    v_add_u32 v10, s67, v3
    v_mul_u32_u24 v10, 1152, v10
    v_mul_u32_u24 v11, 36, v2
    v_add3_u32 v10, v10, v11, s84
    s_barrier
    ds_read_b128 v[128:131], v8 offset:0
    ds_read_b128 v[132:135], v8 offset:1024
    ds_read_b128 v[136:139], v8 offset:2048
    ds_read_b128 v[140:143], v8 offset:3072
    ds_read_b128 v[144:147], v8 offset:4096
    s_waitcnt lgkmcnt(0)
    v_pk_add_f32 v[68:69], v[68:69], v[128:129] neg_lo:[0,1] neg_hi:[0,1]
    v_pk_fma_f32 v[68:69], v[68:69], v[26:27], v[128:129] op_sel_hi:[1,0,1]
    v_pk_add_f32 v[70:71], v[70:71], v[130:131] neg_lo:[0,1] neg_hi:[0,1]
    v_pk_fma_f32 v[70:71], v[70:71], v[26:27], v[130:131] op_sel_hi:[1,0,1]
    v_pk_add_f32 v[72:73], v[72:73], v[132:133] neg_lo:[0,1] neg_hi:[0,1]
    v_pk_fma_f32 v[72:73], v[72:73], v[26:27], v[132:133] op_sel_hi:[1,0,1]
    v_pk_add_f32 v[74:75], v[74:75], v[134:135] neg_lo:[0,1] neg_hi:[0,1]
    v_pk_fma_f32 v[74:75], v[74:75], v[26:27], v[134:135] op_sel_hi:[1,0,1]
    v_pk_add_f32 v[76:77], v[76:77], v[136:137] neg_lo:[0,1] neg_hi:[0,1]
    v_pk_fma_f32 v[76:77], v[76:77], v[26:27], v[136:137] op_sel_hi:[1,0,1]
    v_pk_add_f32 v[78:79], v[78:79], v[138:139] neg_lo:[0,1] neg_hi:[0,1]
    v_pk_fma_f32 v[78:79], v[78:79], v[26:27], v[138:139] op_sel_hi:[1,0,1]
    v_pk_add_f32 v[80:81], v[80:81], v[140:141] neg_lo:[0,1] neg_hi:[0,1]
    v_pk_fma_f32 v[80:81], v[80:81], v[26:27], v[140:141] op_sel_hi:[1,0,1]
    v_pk_add_f32 v[82:83], v[82:83], v[142:143] neg_lo:[0,1] neg_hi:[0,1]
    v_pk_fma_f32 v[82:83], v[82:83], v[26:27], v[142:143] op_sel_hi:[1,0,1]
    v_pk_add_f32 v[84:85], v[84:85], v[144:145] neg_lo:[0,1] neg_hi:[0,1]
    v_pk_fma_f32 v[84:85], v[84:85], v[26:27], v[144:145] op_sel_hi:[1,0,1]
    v_cvt_pk_bf16_f32 v148, v68, v69
    v_cvt_pk_bf16_f32 v149, v70, v71
    v_cvt_pk_bf16_f32 v150, v72, v73
    v_cvt_pk_bf16_f32 v151, v74, v75
    v_cvt_pk_bf16_f32 v152, v76, v77
    v_cvt_pk_bf16_f32 v153, v78, v79
    v_cvt_pk_bf16_f32 v154, v80, v81
    v_cvt_pk_bf16_f32 v155, v82, v83
    v_cvt_pk_bf16_f32 v156, v84, v85
    buffer_store_dwordx4 v[148:151], v10, s[8:11], 0 offen
    buffer_store_dwordx4 v[152:155], v10, s[8:11], 0 offen offset:16
    buffer_store_dword v156, v10, s[8:11], 0 offen offset:32
P3_FIN:
    s_endpgm
K23_SRV:
    s_mul_i32 s85, s83, 1152
    s_add_u32 s85, s85, 0x900000
    s_lshl_b32 s67, s94, 6
    v_add_u32 v19, s67, v1
    v_add_u32 v8, s67, v1
    v_mul_u32_u24 v9, 911, v8
    v_lshrrev_b32 v9, 16, v9
    v_mul_u32_u24 v10, 72, v9
    v_sub_u32 v10, v8, v10
    v_and_b32 v11, 1, v9
    v_lshlrev_b32 v11, 3, v11
    v_xor_b32 v11, v11, v10
    v_bfe_u32 v12, v11, 2, 2
    v_mul_u32_u24 v12, 18, v12
    v_lshrrev_b32 v13, 4, v10
    v_lshl_add_u32 v12, v13, 2, v12
    v_and_b32 v13, 3, v11
    v_add_u32 v12, v12, v13
    v_bfe_u32 v11, v10, 1, 2
    v_mul_u32_u24 v11, 18, v11
    v_and_b32 v13, 1, v10
    v_add3_u32 v11, v11, v13, 16
    v_cmp_lt_u32 vcc, 63, v10
    s_nop 1
    v_cndmask_b32 v12, v12, v11, vcc
    v_mul_u32_u24 v9, 576, v9
    v_add_u32 v12, v12, v9
    v_lshlrev_b32 v16, 4, v12
    s_lshl_b32 s67, s94, 6
    s_add_u32 s67, s67, 256
    v_add_u32 v8, s67, v1
    v_mul_u32_u24 v9, 911, v8
    v_lshrrev_b32 v9, 16, v9
    v_mul_u32_u24 v10, 72, v9
    v_sub_u32 v10, v8, v10
    v_and_b32 v11, 1, v9
    v_lshlrev_b32 v11, 3, v11
    v_xor_b32 v11, v11, v10
    v_bfe_u32 v12, v11, 2, 2
    v_mul_u32_u24 v12, 18, v12
    v_lshrrev_b32 v13, 4, v10
    v_lshl_add_u32 v12, v13, 2, v12
    v_and_b32 v13, 3, v11
    v_add_u32 v12, v12, v13
    v_bfe_u32 v11, v10, 1, 2
    v_mul_u32_u24 v11, 18, v11
    v_and_b32 v13, 1, v10
    v_add3_u32 v11, v11, v13, 16
    v_cmp_lt_u32 vcc, 63, v10
    s_nop 1
    v_cndmask_b32 v12, v12, v11, vcc
    v_mul_u32_u24 v9, 576, v9
    v_add_u32 v12, v12, v9
    v_lshlrev_b32 v18, 4, v12
    s_movk_i32 s67, 512
    v_add_u32 v8, s67, v1
    v_mul_u32_u24 v9, 911, v8
    v_lshrrev_b32 v9, 16, v9
    v_mul_u32_u24 v10, 72, v9
    v_sub_u32 v10, v8, v10
    v_and_b32 v11, 1, v9
    v_lshlrev_b32 v11, 3, v11
    v_xor_b32 v11, v11, v10
    v_bfe_u32 v12, v11, 2, 2
    v_mul_u32_u24 v12, 18, v12
    v_lshrrev_b32 v13, 4, v10
    v_lshl_add_u32 v12, v13, 2, v12
    v_and_b32 v13, 3, v11
    v_add_u32 v12, v12, v13
    v_bfe_u32 v11, v10, 1, 2
    v_mul_u32_u24 v11, 18, v11
    v_and_b32 v13, 1, v10
    v_add3_u32 v11, v11, v13, 16
    v_cmp_lt_u32 vcc, 63, v10
    s_nop 1
    v_cndmask_b32 v12, v12, v11, vcc
    v_mul_u32_u24 v9, 576, v9
    v_add_u32 v12, v12, v9
    v_lshlrev_b32 v17, 4, v12
    s_lshl_b32 s67, s94, 4
    s_mov_b64 s[80:81], 0xffff
    s_lshl_b64 s[80:81], s[80:81], s67
    s_lshl_b32 s77, s94, 10
    v_mul_u32_u24 v21, 3277, v19
    v_lshrrev_b32 v21, 16, v21
    v_mul_u32_u24 v22, 20, v21
    v_sub_u32 v22, v19, v22
    v_lshrrev_b32 v23, 2, v22
    v_mul_u32_u24 v23, 192, v23
    v_and_b32 v25, 3, v22
    v_lshl_add_u32 v23, v25, 4, v23
    v_lshrrev_b32 v25, 1, v21
    v_lshl_add_u32 v23, v25, 6, v23
    v_and_b32 v25, 1, v21
    v_lshl_add_u32 v23, v25, 3, v23
    v_add_u32 v23, 156672, v23
    v_add_u32 v24, 4, v23
    v_add_u32 v25, 832, v23
    v_cmp_lt_u32 vcc, 4, v21
    s_nop 1
    v_cndmask_b32 v23, v23, v25, vcc
    v_add_u32 v25, 832, v24
    v_cmp_lt_u32 vcc, 3, v21
    s_nop 1
    v_cndmask_b32 v24, v24, v25, vcc
    v_mov_b32 v25, 160512
    v_cmp_gt_u32 vcc, 180, v19
    s_nop 1
    v_cndmask_b32 v23, v25, v23, vcc
    v_cndmask_b32 v24, v25, v24, vcc
    v_lshlrev_b32 v8, 4, v19
    v_mov_b32 v10, s75
    v_cndmask_b32 v8, v10, v8, vcc
    s_mul_i32 s67, s60, 16*3072
    s_add_u32 s67, s67, 0x500000
    s_waitcnt lgkmcnt(0)
    s_mov_b32 s16, s34
    s_and_b32 s17, s35, 0xffff
    s_mov_b32 s18, 0x2000000
    s_mov_b32 s19, 0x20000
    buffer_load_dwordx4 v[28:31], v8, s[16:19], s67 offen
    s_add_u32 s67, s67, 3072
    buffer_load_dwordx4 v[32:35], v8, s[16:19], s67 offen
    s_add_u32 s67, s67, 3072
    buffer_load_dwordx4 v[36:39], v8, s[16:19], s67 offen
    s_add_u32 s67, s67, 3072
    buffer_load_dwordx4 v[40:43], v8, s[16:19], s67 offen
    s_add_u32 s67, s67, 3072
    buffer_load_dwordx4 v[44:47], v8, s[16:19], s67 offen
    s_add_u32 s67, s67, 3072
    buffer_load_dwordx4 v[48:51], v8, s[16:19], s67 offen
    s_add_u32 s67, s67, 3072
    buffer_load_dwordx4 v[52:55], v8, s[16:19], s67 offen
    s_add_u32 s67, s67, 3072
    buffer_load_dwordx4 v[56:59], v8, s[16:19], s67 offen
    s_add_u32 s67, s67, 3072
    buffer_load_dwordx4 v[60:63], v8, s[16:19], s67 offen
    s_add_u32 s67, s67, 3072
    buffer_load_dwordx4 v[64:67], v8, s[16:19], s67 offen
    s_add_u32 s67, s67, 3072
    buffer_load_dwordx4 v[68:71], v8, s[16:19], s67 offen
    s_add_u32 s67, s67, 3072
    buffer_load_dwordx4 v[72:75], v8, s[16:19], s67 offen
    s_add_u32 s67, s67, 3072
    buffer_load_dwordx4 v[76:79], v8, s[16:19], s67 offen
    s_add_u32 s67, s67, 3072
    buffer_load_dwordx4 v[80:83], v8, s[16:19], s67 offen
    s_add_u32 s67, s67, 3072
    buffer_load_dwordx4 v[84:87], v8, s[16:19], s67 offen
    s_add_u32 s67, s67, 3072
    buffer_load_dwordx4 v[88:91], v8, s[16:19], s67 offen
    s_barrier
    s_add_u32 m0, s77, 147456
    s_add_u32 s76, s85, 589824
    buffer_load_dwordx4 v16, s[16:19], s76 offen lds
    s_add_u32 m0, s77, 151552
    s_nop 0
    buffer_load_dwordx4 v18, s[16:19], s76 offen lds
    s_mov_b32 m0, 155648
    s_mov_b64 exec, s[80:81]
    buffer_load_dwordx4 v17, s[16:19], s76 offen lds
    s_mov_b64 exec, -1
    s_add_u32 m0, s77, 138240
    s_add_u32 s76, s85, 1253376
    buffer_load_dwordx4 v16, s[16:19], s76 offen lds
    s_add_u32 m0, s77, 142336
    s_nop 0
    buffer_load_dwordx4 v18, s[16:19], s76 offen lds
    s_mov_b32 m0, 146432
    s_mov_b64 exec, s[80:81]
    buffer_load_dwordx4 v17, s[16:19], s76 offen lds
    s_mov_b64 exec, -1
    s_waitcnt vmcnt(6)
    v_pk_add_f32 v[28:29], v[28:29], v[32:33]
    v_pk_add_f32 v[30:31], v[30:31], v[34:35]
    v_pk_add_f32 v[28:29], v[28:29], v[36:37]
    v_pk_add_f32 v[30:31], v[30:31], v[38:39]
    v_pk_add_f32 v[28:29], v[28:29], v[40:41]
    v_pk_add_f32 v[30:31], v[30:31], v[42:43]
    v_pk_add_f32 v[28:29], v[28:29], v[44:45]
    v_pk_add_f32 v[30:31], v[30:31], v[46:47]
    v_pk_add_f32 v[28:29], v[28:29], v[48:49]
    v_pk_add_f32 v[30:31], v[30:31], v[50:51]
    v_pk_add_f32 v[28:29], v[28:29], v[52:53]
    v_pk_add_f32 v[30:31], v[30:31], v[54:55]
    v_pk_add_f32 v[28:29], v[28:29], v[56:57]
    v_pk_add_f32 v[30:31], v[30:31], v[58:59]
    v_pk_add_f32 v[28:29], v[28:29], v[60:61]
    v_pk_add_f32 v[30:31], v[30:31], v[62:63]
    v_pk_add_f32 v[28:29], v[28:29], v[64:65]
    v_pk_add_f32 v[30:31], v[30:31], v[66:67]
    v_pk_add_f32 v[28:29], v[28:29], v[68:69]
    v_pk_add_f32 v[30:31], v[30:31], v[70:71]
    v_pk_add_f32 v[28:29], v[28:29], v[72:73]
    v_pk_add_f32 v[30:31], v[30:31], v[74:75]
    v_pk_add_f32 v[28:29], v[28:29], v[76:77]
    v_pk_add_f32 v[30:31], v[30:31], v[78:79]
    v_pk_add_f32 v[28:29], v[28:29], v[80:81]
    v_pk_add_f32 v[30:31], v[30:31], v[82:83]
    v_pk_add_f32 v[28:29], v[28:29], v[84:85]
    v_pk_add_f32 v[30:31], v[30:31], v[86:87]
    v_pk_add_f32 v[28:29], v[28:29], v[88:89]
    v_pk_add_f32 v[30:31], v[30:31], v[90:91]
    v_cvt_pk_bf16_f32 v32, v28, v29
    v_cvt_pk_bf16_f32 v33, v30, v31
    v_mov_b32 v25, 0x3f803f80
    v_cmp_eq_u32 vcc, 19, v22
    s_nop 1
    v_cndmask_b32 v32, v32, v25, vcc
    v_cndmask_b32 v33, v33, v25, vcc
    ds_write_b32 v23, v32
    ds_write_b32 v24, v33
    s_waitcnt lgkmcnt(0)
    s_waitcnt vmcnt(0)
    s_barrier
    s_add_u32 m0, s77, 0
    s_add_u32 s76, s85, 0
    buffer_load_dwordx4 v16, s[16:19], s76 offen lds
    s_add_u32 m0, s77, 4096
    s_nop 0
    buffer_load_dwordx4 v18, s[16:19], s76 offen lds
    s_mov_b32 m0, 8192
    s_mov_b64 exec, s[80:81]
    buffer_load_dwordx4 v17, s[16:19], s76 offen lds
    s_mov_b64 exec, -1
    s_add_u32 m0, s77, 9216
    s_add_u32 s76, s85, 73728
    buffer_load_dwordx4 v16, s[16:19], s76 offen lds
    s_add_u32 m0, s77, 13312
    s_nop 0
    buffer_load_dwordx4 v18, s[16:19], s76 offen lds
    s_mov_b32 m0, 17408
    s_mov_b64 exec, s[80:81]
    buffer_load_dwordx4 v17, s[16:19], s76 offen lds
    s_mov_b64 exec, -1
    s_add_u32 m0, s77, 18432
    s_add_u32 s76, s85, 147456
    buffer_load_dwordx4 v16, s[16:19], s76 offen lds
    s_add_u32 m0, s77, 22528
    s_nop 0
    buffer_load_dwordx4 v18, s[16:19], s76 offen lds
    s_mov_b32 m0, 26624
    s_mov_b64 exec, s[80:81]
    buffer_load_dwordx4 v17, s[16:19], s76 offen lds
    s_mov_b64 exec, -1
    s_add_u32 m0, s77, 27648
    s_add_u32 s76, s85, 221184
    buffer_load_dwordx4 v16, s[16:19], s76 offen lds
    s_add_u32 m0, s77, 31744
    s_nop 0
    buffer_load_dwordx4 v18, s[16:19], s76 offen lds
    s_mov_b32 m0, 35840
    s_mov_b64 exec, s[80:81]
    buffer_load_dwordx4 v17, s[16:19], s76 offen lds
    s_mov_b64 exec, -1
    s_add_u32 m0, s77, 36864
    s_add_u32 s76, s85, 294912
    buffer_load_dwordx4 v16, s[16:19], s76 offen lds
    s_add_u32 m0, s77, 40960
    s_nop 0
    buffer_load_dwordx4 v18, s[16:19], s76 offen lds
    s_mov_b32 m0, 45056
    s_mov_b64 exec, s[80:81]
    buffer_load_dwordx4 v17, s[16:19], s76 offen lds
    s_mov_b64 exec, -1
    s_add_u32 m0, s77, 46080
    s_add_u32 s76, s85, 368640
    buffer_load_dwordx4 v16, s[16:19], s76 offen lds
    s_add_u32 m0, s77, 50176
    s_nop 0
    buffer_load_dwordx4 v18, s[16:19], s76 offen lds
    s_mov_b32 m0, 54272
    s_mov_b64 exec, s[80:81]
    buffer_load_dwordx4 v17, s[16:19], s76 offen lds
    s_mov_b64 exec, -1
    s_add_u32 m0, s77, 55296
    s_add_u32 s76, s85, 442368
    buffer_load_dwordx4 v16, s[16:19], s76 offen lds
    s_add_u32 m0, s77, 59392
    s_nop 0
    buffer_load_dwordx4 v18, s[16:19], s76 offen lds
    s_mov_b32 m0, 63488
    s_mov_b64 exec, s[80:81]
    buffer_load_dwordx4 v17, s[16:19], s76 offen lds
    s_mov_b64 exec, -1
    s_add_u32 m0, s77, 64512
    s_add_u32 s76, s85, 516096
    buffer_load_dwordx4 v16, s[16:19], s76 offen lds
    s_add_u32 m0, s77, 68608
    s_nop 0
    buffer_load_dwordx4 v18, s[16:19], s76 offen lds
    s_mov_b32 m0, 72704
    s_mov_b64 exec, s[80:81]
    buffer_load_dwordx4 v17, s[16:19], s76 offen lds
    s_mov_b64 exec, -1
    s_add_u32 m0, s77, 73728
    s_add_u32 s76, s85, 663552
    buffer_load_dwordx4 v16, s[16:19], s76 offen lds
    s_add_u32 m0, s77, 77824
    s_nop 0
    buffer_load_dwordx4 v18, s[16:19], s76 offen lds
    s_mov_b32 m0, 81920
    s_mov_b64 exec, s[80:81]
    buffer_load_dwordx4 v17, s[16:19], s76 offen lds
    s_mov_b64 exec, -1
    s_add_u32 m0, s77, 82944
    s_add_u32 s76, s85, 737280
    buffer_load_dwordx4 v16, s[16:19], s76 offen lds
    s_add_u32 m0, s77, 87040
    s_nop 0
    buffer_load_dwordx4 v18, s[16:19], s76 offen lds
    s_mov_b32 m0, 91136
    s_mov_b64 exec, s[80:81]
    buffer_load_dwordx4 v17, s[16:19], s76 offen lds
    s_mov_b64 exec, -1
    s_lshl_b32 s87, s82, 8
    s_add_u32 s87, s87, 0x810000
    v_lshl_add_u32 v20, v1, 2, s87
    s_barrier
    s_add_u32 m0, s77, 92160
    s_add_u32 s76, s85, 811008
    buffer_load_dwordx4 v16, s[16:19], s76 offen lds
    s_add_u32 m0, s77, 96256
    s_nop 0
    buffer_load_dwordx4 v18, s[16:19], s76 offen lds
    s_mov_b32 m0, 100352
    s_mov_b64 exec, s[80:81]
    buffer_load_dwordx4 v17, s[16:19], s76 offen lds
    s_mov_b64 exec, -1
    s_add_u32 m0, s77, 101376
    s_add_u32 s76, s85, 884736
    buffer_load_dwordx4 v16, s[16:19], s76 offen lds
    s_add_u32 m0, s77, 105472
    s_nop 0
    buffer_load_dwordx4 v18, s[16:19], s76 offen lds
    s_mov_b32 m0, 109568
    s_mov_b64 exec, s[80:81]
    buffer_load_dwordx4 v17, s[16:19], s76 offen lds
    s_mov_b64 exec, -1
    s_add_u32 m0, s77, 110592
    s_add_u32 s76, s85, 958464
    buffer_load_dwordx4 v16, s[16:19], s76 offen lds
    s_add_u32 m0, s77, 114688
    s_nop 0
    buffer_load_dwordx4 v18, s[16:19], s76 offen lds
    s_mov_b32 m0, 118784
    s_mov_b64 exec, s[80:81]
    buffer_load_dwordx4 v17, s[16:19], s76 offen lds
    s_mov_b64 exec, -1
    s_add_u32 m0, s77, 119808
    s_add_u32 s76, s85, 1032192
    buffer_load_dwordx4 v16, s[16:19], s76 offen lds
    s_add_u32 m0, s77, 123904
    s_nop 0
    buffer_load_dwordx4 v18, s[16:19], s76 offen lds
    s_mov_b32 m0, 128000
    s_mov_b64 exec, s[80:81]
    buffer_load_dwordx4 v17, s[16:19], s76 offen lds
    s_mov_b64 exec, -1
    s_add_u32 m0, s77, 129024
    s_add_u32 s76, s85, 1105920
    buffer_load_dwordx4 v16, s[16:19], s76 offen lds
    s_add_u32 m0, s77, 133120
    s_nop 0
    buffer_load_dwordx4 v18, s[16:19], s76 offen lds
    s_mov_b32 m0, 137216
    s_mov_b64 exec, s[80:81]
    buffer_load_dwordx4 v17, s[16:19], s76 offen lds
    s_mov_b64 exec, -1
    s_add_u32 m0, s77, 138240
    s_add_u32 s76, s85, 1179648
    buffer_load_dwordx4 v16, s[16:19], s76 offen lds
    s_add_u32 m0, s77, 142336
    s_nop 0
    buffer_load_dwordx4 v18, s[16:19], s76 offen lds
    s_mov_b32 m0, 146432
    s_mov_b64 exec, s[80:81]
    buffer_load_dwordx4 v17, s[16:19], s76 offen lds
    s_mov_b64 exec, -1
    s_mov_b32 s86, 0
    s_cmp_lg_u32 s94, 0
    s_cbranch_scc1 S2_DONE
S2_LOOP:
    buffer_load_dword v8, v20, s[16:19], 0 offen sc1
    s_add_u32 s86, s86, 1
    s_waitcnt vmcnt(0)
    v_cmp_eq_u32 vcc, 1, v8
    s_nop 0
    s_cmp_eq_u64 vcc, -1
    s_cbranch_scc1 S2_DONE
    s_cmp_lt_u32 s86, 1048576
    s_cbranch_scc1 S2_LOOP
S2_DONE:
    s_waitcnt vmcnt(0)
    s_barrier
    s_barrier
    s_barrier
KF_END:
    s_endpgm
.section .rodata,"a"
.p2align 6
.amdhsa_kernel hh_k1_kernel
  .amdhsa_next_free_vgpr 168
  .amdhsa_next_free_sgpr 102
  .amdhsa_accum_offset 168
  .amdhsa_group_segment_fixed_size 0
  .amdhsa_kernarg_size 96
  .amdhsa_user_sgpr_count 2
  .amdhsa_user_sgpr_kernarg_segment_ptr 1
  .amdhsa_system_sgpr_workgroup_id_x 1
.end_amdhsa_kernel
.p2align 6
.amdhsa_kernel hh_k23_kernel
  .amdhsa_next_free_vgpr 168
  .amdhsa_next_free_sgpr 102
  .amdhsa_accum_offset 168
  .amdhsa_group_segment_fixed_size 0
  .amdhsa_kernarg_size 96
  .amdhsa_user_sgpr_count 2
  .amdhsa_user_sgpr_kernarg_segment_ptr 1
  .amdhsa_system_sgpr_workgroup_id_x 1
.end_amdhsa_kernel
```
